```python
import torch

def _softmax(x, axis=-1):
    return torch.softmax(x, dim=axis)
def _gelu(x):
    return torch.nn.functional.gelu(x, approximate="tanh")
def _silu(x):
    return torch.nn.functional.silu(x)
def _sigmoid(x):
    return torch.sigmoid(x)
def _layernorm(x, axis=-1, eps=1e-5):
    m = x.mean(dim=axis, keepdim=True)
    v = x.var(dim=axis, keepdim=True, unbiased=False)
    return (x - m) / torch.sqrt(v + eps)
def _scatter_add(tgt, idx, src, axis=0):
    return tgt.clone().index_add_(axis, idx, src)
def _segment_sum(src, seg, n):
    out = torch.zeros((n,) + src.shape[1:], dtype=src.dtype)
    return out.index_add_(0, seg, src)
def _pad(x, pw):
    flat = tuple(v for pair in reversed(pw) for v in pair)
    return torch.nn.functional.pad(x, flat)

kernel_name = 'concat_heads__mha_block__ssm_conv_h3__prompt'

def setup_inputs():

    _w = (lambda a: (lambda t: t.to(torch.bfloat16) if t.is_floating_point() else t)(torch.as_tensor(a)))
    def _A_setup():
        B, S, D, H = 1, 2048, 512, 32
        return {
            "x": _w((lambda *s: torch.randn(*s, dtype=torch.bfloat16) * 0.2)(B, S, D)),
            "wqkv": _w((lambda *s: torch.randn(*s, dtype=torch.bfloat16) * 0.2)(D, 3 * D)),
            "wo": _w((lambda *s: torch.randn(*s, dtype=torch.bfloat16) * 0.05)(D, D)),
        }
    _A_in = _A_setup()

    def _B_setup():
        B, S, D = 1, 2048, 512
        ks = 4
        return {
            "q": _w((lambda *s: torch.randn(*s, dtype=torch.bfloat16) * 0.05)(B, S, D)),
            "k": _w((lambda *s: torch.randn(*s, dtype=torch.bfloat16) * 0.4)(B, S, D)),
            "v": _w((lambda *s: torch.randn(*s, dtype=torch.bfloat16) * 0.4)(B, S, D)),
            "shift_k": _w((lambda *s: torch.randn(*s, dtype=torch.bfloat16) * 0.4)(D, ks) * 0.5),
            "ssm_k": _w((lambda *s: torch.randn(*s, dtype=torch.bfloat16) * 0.8)(D, S) * (1.0 / S ** 0.5)),
            "ssm_D": _w((lambda *s: torch.randn(*s, dtype=torch.bfloat16) * 0.4)(D)),
        }
    _B_in = _B_setup()

    return {
        "A_x": _A_in["x"],
        "A_wqkv": _A_in["wqkv"],
        "A_wo": _A_in["wo"],
        "B_q": _B_in["q"],
        "B_k": _B_in["k"],
        "B_v": _B_in["v"],
        "B_shift_k": _B_in["shift_k"],
        "B_ssm_k": _B_in["ssm_k"],
        "B_ssm_D": _B_in["ssm_D"],
    }

def reference(A_x, A_wqkv, A_wo, B_q, B_k, B_v, B_shift_k, B_ssm_k, B_ssm_D):
    def _A_ref(x, wqkv, wo):
        B, S, D = x.shape
        H = 32
        Dh = D // H
        qkv = (lambda x, *d: x.permute(*d))((x @ wqkv).reshape(B, S, 3, H, Dh), 2, 0, 3, 1, 4)
        q, k, v = qkv[0], qkv[1], qkv[2]
        scores = torch.einsum("bhqd,bhkd->bhqk", q, k) * (Dh ** -0.5)
        p = _softmax(scores, axis=-1)
        o = torch.einsum("bhqk,bhkd->bhqd", p, v)
        return (lambda x, *d: x.permute(*d))(o, 0, 2, 1, 3).reshape(B, S, D) @ wo

    def _B_ref(q, k, v, shift_k, ssm_k, ssm_D):
        B, S, D = q.shape
        ks = shift_k.shape[-1]
        k_pad = _pad(k, ((0, 0), (ks - 1, 0), (0, 0)))
        k_shift = torch.zeros_like(k)
        for t in range(ks):
            k_shift = k_shift + k_pad[:, t:t + S, :] * shift_k[:, ks - 1 - t][None, None, :]
        kv = k_shift * v
        L = 2 * S
        kv_pad = _pad(kv, ((0, 0), (0, S), (0, 0)))
        kf_pad = _pad(ssm_k, ((0, 0), (0, S)))
        kv_f = (lambda x, axes=(-2,-1): torch.fft.rfft2(x.float(), dim=axes))(kv_pad[:, None, :, :], axes=(1, 2))
        kf_f = (lambda x, axes=(-2,-1): torch.fft.rfft2(x.float(), dim=axes))(kf_pad[:, None, :], axes=(1, 2))
        kf_f = (lambda x, *d: x.permute(*d))(kf_f, 1, 2, 0)
        y_f = kv_f * kf_f[None, :, :, :]
        y = (lambda x, s, axes=(-2,-1): torch.fft.irfft2(x, s=s, dim=axes).to(torch.bfloat16))(y_f, (1, L), axes=(1, 2))[:, 0, :S, :]
        y = y + kv * ssm_D[None, None, :]
        return q * y

    a = _A_ref(A_x, A_wqkv, A_wo)
    b = _B_ref(B_q, B_k, B_v, B_shift_k, B_ssm_k, B_ssm_D)
    return torch.concatenate([a, b], axis=-1)
```

```asm
; @launch grid=(256,1,1) block=(768,1,1) lds=163840
.amdgcn_target "amdgcn-amd-amdhsa--gfx950"
.text
.globl concat_heads__mha_block__ssm_conv_h3__prompt_kernel
.p2align 12
.p2align 8
.type concat_heads__mha_block__ssm_conv_h3__prompt_kernel,@function
concat_heads__mha_block__ssm_conv_h3__prompt_kernel:
    s_load_dwordx2 s[8:9], s[0:1], 0
    s_load_dwordx2 s[12:13], s[0:1], 8
    s_load_dwordx2 s[16:17], s[0:1], 88
    s_cmp_ge_u32 s2, 256
    s_cbranch_scc1 L_end
    v_lshrrev_b32 v1, 6, v0
    v_and_b32 v0, 63, v0
    v_readfirstlane_b32 s3, v1
    v_lshlrev_b32 v14, 4, v0
    s_and_b32 s6, s2, 7
    s_lshr_b32 s7, s2, 3
    s_and_b32 s4, s2, 1
    s_lshl_b32 s4, s4, 3
    s_and_b32 s53, s7, 7
    s_add_u32 s4, s4, s53
    s_and_b32 s5, s2, 6
    s_lshl_b32 s5, s5, 1
    s_lshr_b32 s53, s2, 6
    s_add_u32 s5, s5, s53
    s_mov_b32 s10, 0x200000
    s_mov_b32 s11, 0x20000
    s_mov_b32 s18, 16777216
    s_mov_b32 s19, s11
    s_sub_u32 s54, s3, 4
    s_cbranch_scc1 L_B
    s_mov_b64 exec, 0
    s_cmp_eq_u32 s54, 7
    s_cbranch_scc1 L_stub0
    s_cmp_eq_u32 s54, 6
    s_cbranch_scc1 L_stub1
    s_cmp_eq_u32 s54, 5
    s_cbranch_scc1 L_stub2
    s_cmp_eq_u32 s54, 4
    s_cbranch_scc1 L_stub3
    s_cmp_eq_u32 s54, 3
    s_cbranch_scc1 L_stub4
    s_cmp_eq_u32 s54, 2
    s_cbranch_scc1 L_stub5
    s_cmp_eq_u32 s54, 1
    s_cbranch_scc1 L_stub6
    s_branch L_stub7
L_warm:
    s_mov_b64 exec, -1
    s_cmp_ge_u32 s54, 4
    s_cbranch_scc1 L_G
    s_branch L_P
L_B:
    s_mov_b32 s14, 0x180000
    s_mov_b32 s15, s11
    v_lshrrev_b32 v1, 3, v0
    v_and_b32 v2, 7, v0
    v_lshrrev_b32 v3, 4, v0
    v_xor_b32 v4, v2, v3
    v_lshlrev_b32 v4, 4, v4
    v_lshl_add_u32 v4, v1, 10, v4
    s_lshl_b32 s53, s5, 2
    s_add_u32 s53, s53, s3
    s_lshl_b32 s53, s53, 15
    v_add_u32 v4, s53, v4
    v_xor_b32 v5, 64, v4
    v_add_u32 v5, 7168, v5
    v_and_b32 v3, 1, v3
    v_lshlrev_b32 v3, 2, v3
    v_xor_b32 v3, v2, v3
    v_mul_u32_u24 v6, 3072, v1
    v_lshl_add_u32 v6, v3, 4, v6
    s_mul_i32 s62, s3, 49152
    s_lshr_b32 s53, s4, 1
    s_lshl_b32 s53, s53, 7
    s_add_u32 s53, s53, s62
    s_and_b32 s55, s4, 1
    s_add_u32 s55, s55, 1
    s_lshl_b32 s55, s55, 10
    s_add_u32 s53, s53, s55
    v_add_u32 v6, s53, v6
    v_add_u32 v7, 23552, v6
    s_mul_i32 s60, s4, 4
    s_mul_i32 s53, s5, 4
    s_add_u32 s60, s60, s53
    s_lshr_b32 s53, s5, 2
    s_mul_i32 s53, s53, 1
    s_add_u32 s60, s60, s53
    s_lshr_b32 s53, s4, 3
    s_mul_i32 s53, s53, 2
    s_add_u32 s60, s60, s53
    s_lshl_b32 s55, s3, 12
    s_lshl_b32 s56, s3, 11
    s_add_u32 s56, s56, 131072
    s_mov_b32 s57, 0
    s_waitcnt lgkmcnt(0)
L_ld:
    s_and_b32 s60, s60, 7
    s_mul_i32 s59, s60, 196608
    s_mov_b32 m0, s56
    s_lshl_b32 s58, s60, 7
    buffer_load_dwordx4 v6, s[12:15], s59 offen lds
    buffer_load_dwordx4 v7, s[12:15], s59 offen offset:1024 lds
    s_mov_b32 m0, s55
    s_add_u32 s59, s58, 14336
    buffer_load_dwordx4 v4, s[8:11], s58 offen lds
    buffer_load_dwordx4 v5, s[8:11], s58 offen offset:1024 lds
    buffer_load_dwordx4 v4, s[8:11], s59 offen offset:2048 lds
    buffer_load_dwordx4 v5, s[8:11], s59 offen offset:3072 lds
    s_add_u32 s60, s60, 1
    s_add_u32 s57, s57, 1
    s_add_u32 s55, s55, 0x4000
    s_add_u32 s56, s56, 0x2000
    s_bitset0_b32 s56, 15
    s_cmp_lt_u32 s57, 3
    s_cbranch_scc1 L_ld
    s_waitcnt vmcnt(12)
    s_barrier
    s_cmp_lt_u32 s57, 8
    s_cbranch_scc1 L_ld
    s_waitcnt vmcnt(6)
    s_barrier
    v_lshrrev_b32 v6, 2, v0
    v_mul_u32_u24 v6, 3072, v6
    v_and_b32 v7, 48, v14
    s_lshl_b32 s53, s4, 6
    s_add_u32 s53, s53, s62
    v_add3_u32 v6, v6, v7, s53
    s_lshl_b32 s56, s3, 10
    s_add_u32 s56, s56, 36864
    s_lshr_b32 s61, s5, 1
    s_lshl_b32 s53, s4, 1
    s_add_u32 s61, s61, s53
    s_mov_b32 s57, 0
L_lq0:
    s_and_b32 s53, s61, 3
    s_and_b32 s58, s57, 4
    s_or_b32 s53, s53, s58
    s_lshl_b32 s58, s53, 12
    s_add_u32 m0, s58, s56
    s_add_u32 s53, s53, s60
    s_and_b32 s53, s53, 7
    s_mul_i32 s59, s53, 196608
    buffer_load_dwordx4 v6, s[12:15], s59 offen lds
    s_add_u32 s61, s61, 1
    s_add_u32 s57, s57, 1
    s_cmp_lt_u32 s57, 4
    s_cbranch_scc1 L_lq0
    s_waitcnt vmcnt(4)
    s_barrier
    s_load_dwordx2 s[32:33], s[0:1], 32
    s_load_dwordx2 s[36:37], s[0:1], 40
    s_load_dwordx2 s[40:41], s[0:1], 48
    s_load_dwordx2 s[44:45], s[0:1], 56
    s_load_dwordx2 s[48:49], s[0:1], 64
    s_load_dwordx2 s[24:25], s[0:1], 16
    s_load_dwordx2 s[28:29], s[0:1], 24
    s_load_dwordx2 s[20:21], s[0:1], 72
    s_add_u32 s66, s16, 10682368
    s_addc_u32 s67, s17, 0
    s_load_dword s52, s[66:67], 0
    s_mov_b64 s[34:35], s[10:11]
    s_mov_b64 s[38:39], s[10:11]
    s_movk_i32 s42, 0x1000
    s_mov_b32 s43, s11
    s_lshl_b32 s63, s6, 2
    s_add_u32 s63, s63, s3
    s_lshl_b32 s53, s63, 7
    v_lshl_add_u32 v13, v1, 4, s53
    v_lshlrev_b32 v12, 4, v2
    v_lshl_add_u32 v12, v1, 10, v12
    s_lshl_b32 s53, s7, 9
    s_add_u32 s53, s53, s6
    s_lshl_b32 s53, s53, 7
    v_add_u32 v12, s53, v12
    s_lshl_b32 s53, s3, 14
    v_add_u32 v11, s53, v12
    v_subrev_u32 v12, 0x2000, v12
    s_mul_i32 s62, s3, 2080
    s_waitcnt lgkmcnt(0)
    buffer_load_dwordx4 v[36:39], v13, s[40:43], 0 offen
    s_barrier
L_lq1:
    s_and_b32 s53, s61, 3
    s_and_b32 s58, s57, 4
    s_or_b32 s53, s53, s58
    s_lshl_b32 s58, s53, 12
    s_add_u32 m0, s58, s56
    s_add_u32 s53, s53, s60
    s_and_b32 s53, s53, 7
    s_mul_i32 s59, s53, 196608
    buffer_load_dwordx4 v6, s[12:15], s59 offen lds
    s_add_u32 s61, s61, 1
    s_add_u32 s57, s57, 1
    s_cmp_lt_u32 s57, 8
    s_cbranch_scc1 L_lq1
    s_waitcnt vmcnt(0)
    s_barrier
    s_mov_b64 s[30:31], s[10:11]
    s_mov_b64 s[46:47], s[10:11]
    s_movk_i32 s50, 0x400
    s_mov_b32 s51, s11
    s_mov_b32 s22, 0x400000
    s_mov_b32 s23, s11
    s_mov_b32 s26, 0x80000
    s_mov_b32 s27, s11
    s_movk_i32 s69, 3072
    v_lshrrev_b32 v8, 5, v0
    v_and_b32 v10, 31, v0
    s_lshl_b32 s53, s6, 5
    v_add_u32 v9, s53, v10
    s_and_b32 s55, s3, 1
    s_lshr_b32 s56, s3, 1
    s_lshl_b32 s57, s6, 5
    s_add_u32 s57, s57, s7
    s_lshl_b32 s66, s57, 1
    s_add_u32 s66, s66, s56
    s_lshl_b32 s65, s66, 12
    s_lshl_b32 s66, s66, 1
    s_lshl_b32 s64, s55, 11
    s_add_u32 s64, s64, s65
    s_lshl_b32 s53, s55, 1
    s_sub_u32 s53, s53, 31
    v_add3_u32 v5, v8, v10, s53
    v_lshlrev_b32 v4, 1, v5
    v_lshlrev_b32 v5, 12, v5
    s_mov_b32 s61, 0xffff0000
    v_mul_u32_u24 v15, 1040, v2
    v_lshl_add_u32 v15, v1, 2, v15
    s_lshl_b32 s53, s3, 5
    s_add_u32 s53, s53, 16384
    v_add_u32 v15, s53, v15
    v_lshlrev_b32 v3, 4, v2
    v_lshl_add_u32 v126, v1, 13, v3
    s_lshl_b32 s67, s63, 16
    s_lshl_b32 s53, s7, 7
    s_add_u32 s67, s67, s53
    s_add_u32 s67, s67, 6291456
    s_add_u32 s68, s67, 4096
    v_lshrrev_b32 v1, 4, v0
    v_and_b32 v2, 15, v0
    s_mul_i32 s59, s56, 5120
    s_add_u32 s59, s59, 98816
    v_mul_u32_u24 v127, 1280, v1
    v_lshl_add_u32 v127, v2, 4, v127
    v_add_u32 v127, s59, v127
    v_and_b32 v3, 3, v0
    v_mul_u32_u24 v128, 1280, v3
    v_lshrrev_b32 v6, 2, v0
    v_lshl_add_u32 v128, v6, 4, v128
    s_lshl_b32 s53, s55, 9
    s_add_u32 s53, s53, s59
    v_add_u32 v128, s53, v128
    v_mul_u32_u24 v129, 4160, v3
    v_and_b32 v3, 12, v0
    v_lshl_add_u32 v129, v3, 1, v129
    v_lshlrev_b32 v3, 4, v1
    v_sub_u32 v129, v129, v3
    s_mul_i32 s58, s56, 16640
    s_add_u32 s58, s58, 65536
    s_lshl_b32 s53, s55, 5
    s_add_u32 s53, s53, s58
    v_add3_u32 v129, v129, s53, 48
L_stub7:
    s_cbranch_execz L_stub8
    s_nop 0
    s_lshl_b32 s53, s55, 11
    s_add_u32 s53, s53, s58
    v_add_u32 v130, s53, v14
    s_mul_i32 s53, s55, 8320
    s_add_u32 s53, s53, s58
    v_mul_u32_u24 v131, 4160, v8
    v_lshl_add_u32 v131, v10, 1, v131
    v_add_u32 v131, s53, v131
    v_lshlrev_b32 v3, 2, v1
    v_xor_b32 v3, v2, v3
    v_lshlrev_b32 v3, 4, v3
    v_lshl_add_u32 v132, v1, 10, v3
    v_add_u32 v133, s69, v132
    v_add_u32 v134, s69, v133
    v_add_u32 v135, s69, v134
    v_lshlrev_b32 v136, 7, v2
    s_bfe_u32 s53, s7, 0x10003
    s_lshl_b32 s59, s53, 10
    s_and_b32 s53, s7, 1
    s_lshl_b32 s53, s53, 8
    s_add_u32 s59, s59, s53
    s_and_b32 s53, s7, 16
    s_add_u32 s59, s59, s53
    s_and_b32 s53, s7, 6
    s_lshl_b32 s53, s53, 1
    s_add_u32 s59, s59, s53
    s_lshl_b32 s53, s3, 6
    s_add_u32 s59, s59, s53
    s_lshl_b32 s59, s59, 3
    s_add_u32 s59, s59, s6
    s_lshl_b32 s59, s59, 7
    v_and_b32 v2, 0x70, v14
    v_bfe_u32 v3, v0, 3, 2
    v_lshl_add_u32 v137, v3, 10, v2
    v_lshl_add_u32 v137, v8, 19, v137
    v_add_u32 v137, s59, v137
    v_lshrrev_b32 v3, 3, v0
    v_lshl_add_u32 v140, v3, 12, v2
    s_mul_i32 s53, s3, 2080
    s_add_u32 s53, s53, 149504
    v_add_u32 v138, s53, v14
    v_bfe_u32 v1, v0, 2, 2
    v_lshl_add_u32 v3, v8, 2, v1
    v_xor_b32 v1, s3, v1
    v_lshlrev_b32 v1, 6, v1
    v_lshl_add_u32 v1, v3, 8, v1
    v_and_b32 v3, 1, v0
    v_lshl_add_u32 v1, v3, 5, v1
    v_and_b32 v3, 16, v0
    v_add_u32 v1, v1, v3
    v_and_b32 v3, 2, v0
    v_lshl_add_u32 v1, v3, 2, v1
    v_add_u32 v2, 0x10000, v1
    v_lshlrev_b32 v141, 7, v10
    v_mov_b32 v139, 131072
    s_lshl_b32 s53, s56, 2
    v_add_u32 v142, s53, v139
    v_mov_b32 v143, 1
    v_mov_b64 v[144:145], -1
    v_mov_b64 v[146:147], -1
    v_lshl_add_u32 v3, v0, 2, v139
    v_mov_b32 v6, 0
    s_lshl_b32 s63, s5, 4
    s_add_u32 s63, s63, s4
    s_lshl_b32 s63, s63, 11
    s_add_u32 s63, s63, 11534336
    s_mul_i32 s52, s52, 1664525
    s_add_u32 s52, s52, 1013904223
    v_lshlrev_b32 v44, 16, v36
    v_lshlrev_b32 v45, 16, v38
    v_and_b32 v46, s61, v36
    v_and_b32 v47, s61, v38
    v_lshlrev_b32 v48, 16, v37
    v_lshlrev_b32 v49, 16, v39
    v_and_b32 v50, s61, v37
    v_and_b32 v51, s61, v39
    v_mov_b64 v[16:17], 0
    v_mov_b64 v[18:19], 0
    v_mov_b64 v[20:21], 0
    v_mov_b64 v[22:23], 0
    v_mov_b64 v[24:25], 0
    v_mov_b64 v[26:27], 0
    v_mov_b64 v[28:29], 0
    v_mov_b64 v[30:31], 0
    v_mov_b64 v[52:53], 0
    v_mov_b64 v[54:55], 0
    v_mov_b64 v[56:57], 0
    v_mov_b64 v[58:59], 0
    v_mov_b64 v[60:61], 0
    v_mov_b64 v[62:63], 0
    v_mov_b64 v[64:65], 0
    v_mov_b64 v[66:67], 0
    v_mov_b64 v[68:69], 0
    v_mov_b64 v[70:71], 0
    v_mov_b64 v[72:73], 0
    v_mov_b64 v[76:77], 0
    v_mov_b64 v[78:79], 0
    v_mov_b64 v[80:81], 0
    v_mov_b64 v[82:83], 0
    v_mov_b64 v[84:85], 0
    v_mov_b64 v[86:87], 0
    v_mov_b64 v[88:89], 0
    v_mov_b64 v[90:91], 0
    ds_write_b32 v3, v6
    s_waitcnt lgkmcnt(0)
    s_lshr_b32 s58, s4, 1
    s_lshl_b32 s58, s58, 12
    s_lshl_b32 s53, s3, 15
    s_add_u32 s58, s58, s53
    s_add_u32 s58, s58, 10485760
    s_mov_b32 exec_hi, 0
    s_barrier
    s_setprio 3
    s_barrier
    s_mov_b32 s53, 262144
L_wst:
    buffer_load_dword v3, v141, s[16:19], s58 offen sc1
    s_sub_u32 s53, s53, 1
    s_cbranch_scc1 L_wst_x
    s_waitcnt vmcnt(0)
    v_cmp_ne_u32 vcc, s52, v3
    s_cbranch_vccz L_wst_x
    s_sleep 4
    s_branch L_wst
L_wst_x:
    s_mov_b64 exec, 1
    v_mov_b32 v7, 0x100
    ds_add_u32 v139, v7 offset:12
    s_mov_b64 exec, -1
    s_mov_b32 m0, 16384
    s_nop 0
    buffer_load_dwordx4 v12, s[32:35], 0 offen lds
    s_add_u32 m0, s62, 17424
    s_movk_i32 s53, 7152
    buffer_load_dwordx4 v11, s[32:35], 0 offen lds
    buffer_load_dwordx4 v11, s[32:35], s53 offen offset:1040 lds
    s_waitcnt vmcnt(0)
    s_add_u32 m0, s62, 25744
    s_movk_i32 s53, 7152
    buffer_load_dwordx4 v11, s[36:39], 0 offen lds
    buffer_load_dwordx4 v11, s[36:39], s53 offen offset:1040 lds
    s_waitcnt vmcnt(0)
    s_mov_b64 exec, 1
    ds_add_u32 v139, v143 offset:24
    s_mov_b64 exec, -1
    s_mov_b32 s53, 2097152
L_raw:
    ds_read_b32 v6, v139 offset:24
    s_sub_u32 s53, s53, 1
    s_cbranch_scc1 L_raw_x
    s_waitcnt lgkmcnt(0)
    v_cmp_ne_u32 vcc, 4, v6
    s_cbranch_vccz L_raw_x
    s_sleep 1
    s_branch L_raw
L_raw_x:
    ds_read_u16_d16_hi v52, v15 offset:640
    ds_read_u16_d16_hi v53, v15 offset:642
    ds_read_u16_d16_hi v54, v15 offset:768
    ds_read_u16_d16_hi v55, v15 offset:770
    ds_read_u16_d16_hi v56, v15 offset:896
    ds_read_u16_d16_hi v57, v15 offset:898
    ds_read_u16_d16_hi v58, v15 offset:1040
    ds_read_u16_d16_hi v59, v15 offset:1042
    ds_read_u16_d16_hi v60, v15 offset:1168
    ds_read_u16_d16_hi v61, v15 offset:1170
    ds_read_u16_d16_hi v62, v15 offset:1296
    ds_read_u16_d16_hi v63, v15 offset:1298
    ds_read_u16_d16_hi v64, v15 offset:1424
    ds_read_u16_d16_hi v65, v15 offset:1426
    ds_read_u16_d16_hi v66, v15 offset:1552
    ds_read_u16_d16_hi v67, v15 offset:1554
    ds_read_u16_d16_hi v68, v15 offset:1680
    ds_read_u16_d16_hi v69, v15 offset:1682
    ds_read_u16_d16_hi v70, v15 offset:1808
    ds_read_u16_d16_hi v71, v15 offset:1810
    ds_read_u16_d16_hi v72, v15 offset:1936
    ds_read_u16_d16_hi v73, v15 offset:1938
    ds_read_u16_d16_hi v76, v15 offset:9360
    ds_read_u16_d16_hi v77, v15 offset:9362
    ds_read_u16_d16_hi v78, v15 offset:9488
    ds_read_u16_d16_hi v79, v15 offset:9490
    ds_read_u16_d16_hi v80, v15 offset:9616
    ds_read_u16_d16_hi v81, v15 offset:9618
    ds_read_u16_d16_hi v82, v15 offset:9744
    ds_read_u16_d16_hi v83, v15 offset:9746
    ds_read_u16_d16_hi v84, v15 offset:9872
L_stub8:
    s_cbranch_execz L_warm
    s_nop 0
    ds_read_u16_d16_hi v85, v15 offset:9874
    ds_read_u16_d16_hi v86, v15 offset:10000
    ds_read_u16_d16_hi v87, v15 offset:10002
    ds_read_u16_d16_hi v88, v15 offset:10128
    ds_read_u16_d16_hi v89, v15 offset:10130
    ds_read_u16_d16_hi v90, v15 offset:10256
    ds_read_u16_d16_hi v91, v15 offset:10258
    s_waitcnt lgkmcnt(15)
    v_pk_mul_f32 v[92:93], v[44:45], v[58:59]
    v_pk_mul_f32 v[94:95], v[44:45], v[60:61]
    v_pk_mul_f32 v[96:97], v[44:45], v[62:63]
    v_pk_mul_f32 v[98:99], v[44:45], v[64:65]
    v_pk_mul_f32 v[100:101], v[44:45], v[66:67]
    v_pk_mul_f32 v[102:103], v[44:45], v[68:69]
    v_pk_mul_f32 v[104:105], v[44:45], v[70:71]
    v_pk_mul_f32 v[106:107], v[44:45], v[72:73]
    v_pk_fma_f32 v[92:93], v[46:47], v[56:57], v[92:93]
    v_pk_fma_f32 v[94:95], v[46:47], v[58:59], v[94:95]
    v_pk_fma_f32 v[96:97], v[46:47], v[60:61], v[96:97]
    v_pk_fma_f32 v[98:99], v[46:47], v[62:63], v[98:99]
    v_pk_fma_f32 v[100:101], v[46:47], v[64:65], v[100:101]
    v_pk_fma_f32 v[102:103], v[46:47], v[66:67], v[102:103]
    v_pk_fma_f32 v[104:105], v[46:47], v[68:69], v[104:105]
    v_pk_fma_f32 v[106:107], v[46:47], v[70:71], v[106:107]
    v_pk_fma_f32 v[92:93], v[48:49], v[54:55], v[92:93]
    v_pk_fma_f32 v[94:95], v[48:49], v[56:57], v[94:95]
    v_pk_fma_f32 v[96:97], v[48:49], v[58:59], v[96:97]
    v_pk_fma_f32 v[98:99], v[48:49], v[60:61], v[98:99]
    v_pk_fma_f32 v[100:101], v[48:49], v[62:63], v[100:101]
    v_pk_fma_f32 v[102:103], v[48:49], v[64:65], v[102:103]
    v_pk_fma_f32 v[104:105], v[48:49], v[66:67], v[104:105]
    v_pk_fma_f32 v[106:107], v[48:49], v[68:69], v[106:107]
    v_pk_fma_f32 v[92:93], v[50:51], v[52:53], v[92:93]
    v_pk_fma_f32 v[94:95], v[50:51], v[54:55], v[94:95]
    v_pk_fma_f32 v[96:97], v[50:51], v[56:57], v[96:97]
    v_pk_fma_f32 v[98:99], v[50:51], v[58:59], v[98:99]
    v_pk_fma_f32 v[100:101], v[50:51], v[60:61], v[100:101]
    v_pk_fma_f32 v[102:103], v[50:51], v[62:63], v[102:103]
    v_pk_fma_f32 v[104:105], v[50:51], v[64:65], v[104:105]
    v_pk_fma_f32 v[106:107], v[50:51], v[66:67], v[106:107]
    s_waitcnt lgkmcnt(0)
    v_pk_mul_f32 v[92:93], v[92:93], v[76:77]
    v_pk_mul_f32 v[94:95], v[94:95], v[78:79]
    v_pk_mul_f32 v[96:97], v[96:97], v[80:81]
    v_pk_mul_f32 v[98:99], v[98:99], v[82:83]
    v_pk_mul_f32 v[100:101], v[100:101], v[84:85]
    v_pk_mul_f32 v[102:103], v[102:103], v[86:87]
    v_pk_mul_f32 v[104:105], v[104:105], v[88:89]
    v_pk_mul_f32 v[106:107], v[106:107], v[90:91]
    v_cvt_pk_bf16_f32 v52, v106, v104
    v_cvt_pk_bf16_f32 v53, v102, v100
    v_cvt_pk_bf16_f32 v54, v98, v96
    v_cvt_pk_bf16_f32 v55, v94, v92
    v_cvt_pk_bf16_f32 v56, v107, v105
    v_cvt_pk_bf16_f32 v57, v103, v101
    v_cvt_pk_bf16_f32 v58, v99, v97
    v_cvt_pk_bf16_f32 v59, v95, v93
    buffer_store_dwordx4 v[52:55], v126, s[16:19], s67 offen sc1
    buffer_store_dwordx4 v[56:59], v126, s[16:19], s68 offen sc1
    s_lshl_b32 s67, s57, 7
    s_add_u32 s67, s67, 10616832
    buffer_load_dwordx4 v[112:115], v14, s[44:47], s64 offen
    buffer_load_dwordx2 v[116:117], v14, s[44:47], s64 offen offset:16
    buffer_load_dwordx4 v[120:123], v14, s[44:47], s64 offen offset:1024
    buffer_load_dwordx2 v[124:125], v14, s[44:47], s64 offen offset:1040
    buffer_load_ushort v118, v4, s[44:47], s65 offen
    buffer_load_ushort v119, v5, s[48:51], s66 offen
    s_cmp_lg_u32 s3, 0
    s_cbranch_scc1 L_nh
    s_mov_b64 exec, 0xffff
    v_mov_b32 v3, 0
    buffer_atomic_or v3, v136, s[16:19], s63 offen sc1
    s_mov_b64 exec, -1
L_nh:
    s_waitcnt vmcnt(0) lgkmcnt(0)
    v_mov_b32 v6, 131072
    v_mov_b32 v7, 1
    s_mov_b64 exec, 1
    ds_add_rtn_u32 v7, v6, v7 offset:0
    s_waitcnt lgkmcnt(0)
    v_cmp_eq_u32 vcc, 3, v7
    v_mov_b32 v7, s52
    s_cbranch_vccz L_pb1
    buffer_store_dword v7, off, s[16:19], s67 sc1
L_pb1:
    s_mov_b64 exec, -1
    v_alignbit_b32 v40, v113, v112, 16
    v_alignbit_b32 v48, v114, v113, 16
    v_mov_b32 v44, v113
    v_alignbit_b32 v41, v114, v113, 16
    v_alignbit_b32 v49, v115, v114, 16
    v_mov_b32 v45, v114
    v_alignbit_b32 v42, v115, v114, 16
    v_alignbit_b32 v50, v116, v115, 16
    v_mov_b32 v46, v115
    v_alignbit_b32 v43, v116, v115, 16
    v_alignbit_b32 v51, v117, v116, 16
    v_mov_b32 v47, v116
    v_alignbit_b32 v52, v121, v120, 16
    v_alignbit_b32 v60, v122, v121, 16
    v_mov_b32 v56, v121
    v_alignbit_b32 v53, v122, v121, 16
    v_alignbit_b32 v61, v123, v122, 16
    v_mov_b32 v57, v122
    v_alignbit_b32 v54, v123, v122, 16
    v_alignbit_b32 v62, v124, v123, 16
    v_mov_b32 v58, v123
    v_alignbit_b32 v55, v124, v123, 16
    v_alignbit_b32 v63, v125, v124, 16
    v_mov_b32 v59, v124
    v_lshlrev_b32 v4, 16, v118
    v_lshlrev_b32 v5, 16, v119
    v_add_f32 v4, v4, v5
    v_cvt_pk_bf16_f32 v4, v4, v4
    ds_write_b128 v130, v[40:43] offset:64
    ds_write_b128 v130, v[44:47] offset:4224
    ds_write_b128 v130, v[48:51] offset:8384
    ds_write_b128 v130, v[114:117] offset:12544
    ds_write_b128 v130, v[52:55] offset:1088
    ds_write_b128 v130, v[56:59] offset:5248
    ds_write_b128 v130, v[60:63] offset:9408
    ds_write_b128 v130, v[122:125] offset:13568
    ds_write_b16 v131, v4
    ds_write_b128 v127, v[16:19]
    v_add_u32 v127, 224, v127
    s_and_b32 s53, s4, 6
    s_lshl_b32 s53, s53, 7
    s_lshl_b32 s66, s3, 14
    s_add_u32 s66, s66, s53
    s_lshl_b32 s68, s3, 12
    s_mov_b32 s53, 2097152
L_d0:
    ds_read_b32 v6, v139 offset:0
    s_sub_u32 s53, s53, 1
    s_cbranch_scc1 L_d0_x
    s_waitcnt lgkmcnt(0)
    v_cmp_ne_u32 vcc, 4, v6
    s_cbranch_vccz L_d0_x
    s_sleep 2
    s_branch L_d0
L_d0_x:
    s_mov_b32 s59, 0
L_wo0:
    s_add_u32 s53, s59, s5
    s_and_b32 s53, s53, 3
    s_lshl_b32 s58, s53, 14
    s_add_u32 m0, s58, s68
    s_lshl_b32 s53, s53, 16
    s_add_u32 s53, s53, s66
    buffer_load_dwordx4 v132, s[24:27], s53 offen lds
    buffer_load_dwordx4 v133, s[24:27], s53 offen offset:1024 lds
    buffer_load_dwordx4 v134, s[24:27], s53 offen offset:2048 lds
    buffer_load_dwordx4 v135, s[24:27], s53 offen offset:3072 lds
    s_add_u32 s59, s59, 1
    s_waitcnt vmcnt(2)
    s_cmp_lt_u32 s59, 4
L_stub9:
    s_cbranch_execz L_warm
    s_nop 0
    s_cbranch_scc1 L_wo0
    s_lshl_b32 s62, s6, 12
    s_add_u32 s62, s62, 10616832
    s_add_u32 s64, s64, 6291456
    s_mov_b32 exec_hi, 0
    s_mov_b32 s53, 262144
L_wb1:
    buffer_load_dword v3, v141, s[16:19], s62 offen sc1
    s_sub_u32 s53, s53, 1
    s_cbranch_scc1 L_wb1_x
    s_waitcnt vmcnt(0)
    v_cmp_ne_u32 vcc, s52, v3
    s_cbranch_vccz L_wb1_x
    s_sleep 16
    s_branch L_wb1
L_wb1_x:
    s_mov_b32 exec_hi, -1
    buffer_load_dwordx4 v[32:35], v14, s[16:19], s64 offen sc1
    buffer_load_dwordx4 v[36:39], v14, s[16:19], s64 offen offset:1024 sc1
    s_mov_b32 s59, 8
    s_waitcnt vmcnt(1)
    ds_write_b128 v128, v[32:35] offset:256
    s_waitcnt vmcnt(0)
    ds_write_b128 v128, v[36:39] offset:512
    s_mov_b64 exec, 1
    ds_add_u32 v142, v143 offset:16
    s_mov_b64 exec, -1
    s_lshl_b32 s53, s3, 11
    s_add_u32 m0, s53, 141312
    s_movk_i32 s53, 31744
    buffer_load_dwordx4 v137, s[28:31], 0 offen lds
    buffer_load_dwordx4 v137, s[28:31], s53 offen offset:1024 lds
    s_mov_b32 s53, 2097152
L_pair:
    ds_read_b32 v6, v142 offset:16
    s_sub_u32 s53, s53, 1
    s_cbranch_scc1 L_pair_x
    s_waitcnt lgkmcnt(0)
    v_cmp_ne_u32 vcc, 2, v6
    s_cbranch_vccz L_pair_x
    s_sleep 2
    s_branch L_pair
L_pair_x:
    s_setprio 0
    ds_read_b64 v[32:33], v129 offset:0
    ds_read_b64 v[34:35], v129 offset:8
    ds_read_b128 v[48:51], v127 offset:32
    ds_read_b128 v[52:55], v127 offset:288
    ds_read_b128 v[56:59], v127 offset:544
    ds_read_b128 v[60:63], v127 offset:800
    ds_read_b64 v[36:37], v129 offset:1024
    ds_read_b64 v[38:39], v129 offset:1032
    ds_read_b64 v[40:41], v129 offset:2048
    ds_read_b64 v[42:43], v129 offset:2056
    ds_read_b64 v[44:45], v129 offset:3072
    ds_read_b64 v[46:47], v129 offset:3080
.p2align 3
L_conv:
    s_waitcnt lgkmcnt(6)
    s_sub_u32 s59, s59, 1
    v_mfma_f32_16x16x32_bf16 v[16:19], v[32:35], v[48:51], v[16:19]
    ds_read_b64 v[64:65], v129 offset:64
    ds_read_b64 v[66:67], v129 offset:72
    v_mfma_f32_16x16x32_bf16 v[20:23], v[32:35], v[52:55], v[20:23]
    ds_read_b128 v[80:83], v127 offset:16
    v_mfma_f32_16x16x32_bf16 v[24:27], v[32:35], v[56:59], v[24:27]
    ds_read_b128 v[84:87], v127 offset:272
    v_mfma_f32_16x16x32_bf16 v[28:31], v[32:35], v[60:63], v[28:31]
    ds_read_b128 v[88:91], v127 offset:528
    s_waitcnt lgkmcnt(9)
    s_nop 0
    v_mfma_f32_16x16x32_bf16 v[20:23], v[36:39], v[48:51], v[20:23]
    ds_read_b128 v[92:95], v127 offset:784
    v_mfma_f32_16x16x32_bf16 v[24:27], v[36:39], v[52:55], v[24:27]
    ds_read_b64 v[68:69], v129 offset:1088
    v_mfma_f32_16x16x32_bf16 v[28:31], v[36:39], v[56:59], v[28:31]
    ds_read_b64 v[70:71], v129 offset:1096
    s_waitcnt lgkmcnt(8)
    s_cmp_lg_u32 s59, 0
    v_mfma_f32_16x16x32_bf16 v[24:27], v[40:43], v[48:51], v[24:27]
    ds_read_b64 v[72:73], v129 offset:2112
    ds_read_b64 v[74:75], v129 offset:2120
    v_mfma_f32_16x16x32_bf16 v[28:31], v[40:43], v[52:55], v[28:31]
    ds_read_b64 v[76:77], v129 offset:3136
    v_mfma_f32_16x16x32_bf16 v[28:31], v[44:47], v[48:51], v[28:31]
    ds_read_b64 v[78:79], v129 offset:3144
    s_waitcnt lgkmcnt(6)
    s_nop 0
    v_mfma_f32_16x16x32_bf16 v[16:19], v[64:67], v[80:83], v[16:19]
    ds_read_b64 v[32:33], v129 offset:128
    ds_read_b64 v[34:35], v129 offset:136
    v_mfma_f32_16x16x32_bf16 v[20:23], v[64:67], v[84:87], v[20:23]
    ds_read_b128 v[48:51], v127 offset:0
    v_mfma_f32_16x16x32_bf16 v[24:27], v[64:67], v[88:91], v[24:27]
    ds_read_b128 v[52:55], v127 offset:256
    v_mfma_f32_16x16x32_bf16 v[28:31], v[64:67], v[92:95], v[28:31]
    ds_read_b128 v[56:59], v127 offset:512
    s_waitcnt lgkmcnt(9)
    s_nop 0
    v_mfma_f32_16x16x32_bf16 v[20:23], v[68:71], v[80:83], v[20:23]
    ds_read_b128 v[60:63], v127 offset:768
    v_mfma_f32_16x16x32_bf16 v[24:27], v[68:71], v[84:87], v[24:27]
    ds_read_b64 v[36:37], v129 offset:1152
    v_mfma_f32_16x16x32_bf16 v[28:31], v[68:71], v[88:91], v[28:31]
    ds_read_b64 v[38:39], v129 offset:1160
    s_waitcnt lgkmcnt(8)
    s_nop 0
    v_mfma_f32_16x16x32_bf16 v[24:27], v[72:75], v[80:83], v[24:27]
    ds_read_b64 v[40:41], v129 offset:2176
    ds_read_b64 v[42:43], v129 offset:2184
    v_mfma_f32_16x16x32_bf16 v[28:31], v[72:75], v[84:87], v[28:31]
    ds_read_b64 v[44:45], v129 offset:3200
    v_mfma_f32_16x16x32_bf16 v[28:31], v[76:79], v[80:83], v[28:31]
    ds_read_b64 v[46:47], v129 offset:3208
    v_add_u32 v129, 128, v129
    v_subrev_u32 v127, 32, v127
    s_cbranch_scc1 L_conv
    s_setprio 3
    s_add_u32 s53, s64, 2097152
    s_lshl_b32 s59, s5, 2
    s_add_u32 s59, s59, s3
    s_lshl_b32 s59, s59, 4
    s_add_u32 s59, s59, s4
    s_lshl_b32 s59, s59, 11
    s_add_u32 s59, s59, 4194304
    s_add_u32 s67, s67, 32768
    s_nop 1
    v_cvt_pk_bf16_f32 v96, v16, v17
    v_cvt_pk_bf16_f32 v97, v18, v19
    v_cvt_pk_bf16_f32 v98, v20, v21
    v_cvt_pk_bf16_f32 v99, v22, v23
    v_cvt_pk_bf16_f32 v100, v24, v25
    v_cvt_pk_bf16_f32 v101, v26, v27
    v_cvt_pk_bf16_f32 v102, v28, v29
    v_cvt_pk_bf16_f32 v103, v30, v31
    buffer_store_dwordx4 v[96:99], v14, s[16:19], s53 offen sc1
    buffer_store_dwordx4 v[100:103], v14, s[16:19], s53 offen offset:1024 sc1
    buffer_store_dwordx4 v[144:147], v14, s[16:19], s59 offen sc1
    buffer_store_dwordx4 v[144:147], v14, s[16:19], s59 offen offset:1024 sc1
    s_waitcnt vmcnt(0) lgkmcnt(0)
    v_mov_b32 v6, 131072
    v_mov_b32 v7, 1
    s_mov_b64 exec, 1
    ds_add_rtn_u32 v7, v6, v7 offset:4
    s_waitcnt lgkmcnt(0)
    v_cmp_eq_u32 vcc, 3, v7
    v_mov_b32 v7, s52
    s_cbranch_vccz L_pb2
    buffer_store_dword v7, off, s[16:19], s67 sc1
L_pb2:
    s_mov_b64 exec, -1
    s_mov_b32 s53, 2097152
L_d1:
    ds_read_b32 v6, v139 offset:4
    s_sub_u32 s53, s53, 1
    s_cbranch_scc1 L_d1_x
    s_waitcnt lgkmcnt(0)
    v_cmp_ne_u32 vcc, 4, v6
    s_cbranch_vccz L_d1_x
    s_sleep 2
    s_branch L_d1
L_d1_x:
    s_mov_b32 s59, 0
L_wo1:
    s_add_u32 s53, s59, s5
    s_and_b32 s53, s53, 3
    s_add_u32 s53, s53, 4
    s_lshl_b32 s58, s53, 14
    s_add_u32 m0, s58, s68
    s_lshl_b32 s53, s53, 16
    s_add_u32 s53, s53, s66
    buffer_load_dwordx4 v132, s[24:27], s53 offen lds
L_stub10:
    s_cbranch_execz L_warm
    s_nop 0
    buffer_load_dwordx4 v133, s[24:27], s53 offen offset:1024 lds
    buffer_load_dwordx4 v134, s[24:27], s53 offen offset:2048 lds
    buffer_load_dwordx4 v135, s[24:27], s53 offen offset:3072 lds
    s_add_u32 s59, s59, 1
    s_waitcnt vmcnt(2)
    s_cmp_lt_u32 s59, 4
    s_cbranch_scc1 L_wo1
    s_add_u32 s62, s62, 32768
    s_mov_b32 exec_hi, 0
    s_mov_b32 s53, 262144
L_wb2:
    buffer_load_dword v3, v141, s[16:19], s62 offen sc1
    s_sub_u32 s53, s53, 1
    s_cbranch_scc1 L_wb2_x
    s_waitcnt vmcnt(0)
    v_cmp_ne_u32 vcc, s52, v3
    s_cbranch_vccz L_wb2_x
    s_sleep 16
    s_branch L_wb2
L_wb2_x:
    s_mov_b64 exec, 1
    v_mov_b32 v7, 1
    ds_add_u32 v139, v7 offset:8
    s_mov_b64 exec, -1
    s_lshl_b32 s58, s6, 2
    s_add_u32 s58, s58, s3
    s_lshl_b32 s58, s58, 9
    s_add_u32 s58, s58, s7
    s_lshl_b32 s58, s58, 7
    s_add_u32 s58, s58, 8388608
    s_add_u32 s59, s58, 0x8000
    buffer_load_dwordx4 v[16:19], v140, s[16:19], s58 offen sc1
    buffer_load_dwordx4 v[20:23], v140, s[16:19], s59 offen sc1
    s_waitcnt vmcnt(1)
    ds_write_b128 v138, v[16:19]
    s_waitcnt vmcnt(0)
    ds_write_b128 v138, v[20:23] offset:1040
    v_mov_b32 v5, v139
    s_mov_b32 s53, 2097152
L_d2:
    ds_read_b32 v6, v5 offset:8
    s_sub_u32 s53, s53, 1
    s_cbranch_scc1 L_d2_x
    s_waitcnt lgkmcnt(0)
    v_cmp_ne_u32 vcc, 4, v6
    s_cbranch_vccz L_d2_x
    s_sleep 2
    s_branch L_d2
L_d2_x:
    ds_read_b64_tr_b16 v[40:41], v1 offset:0
    ds_read_b64_tr_b16 v[42:43], v1 offset:2048
    ds_read_b64_tr_b16 v[44:45], v1 offset:4096
    ds_read_b64_tr_b16 v[46:47], v1 offset:6144
    ds_read_b64_tr_b16 v[48:49], v1 offset:8192
    ds_read_b64_tr_b16 v[50:51], v1 offset:10240
    ds_read_b64_tr_b16 v[52:53], v1 offset:12288
    ds_read_b64_tr_b16 v[54:55], v1 offset:14336
    ds_read_b64_tr_b16 v[56:57], v1 offset:16384
    ds_read_b64_tr_b16 v[58:59], v1 offset:18432
    ds_read_b64_tr_b16 v[60:61], v1 offset:20480
    ds_read_b64_tr_b16 v[62:63], v1 offset:22528
    ds_read_b64_tr_b16 v[64:65], v1 offset:24576
    ds_read_b64_tr_b16 v[66:67], v1 offset:26624
    ds_read_b64_tr_b16 v[68:69], v1 offset:28672
    ds_read_b64_tr_b16 v[70:71], v1 offset:30720
    ds_read_b64_tr_b16 v[72:73], v1 offset:32768
    ds_read_b64_tr_b16 v[74:75], v1 offset:34816
    ds_read_b64_tr_b16 v[76:77], v1 offset:36864
    ds_read_b64_tr_b16 v[78:79], v1 offset:38912
    ds_read_b64_tr_b16 v[80:81], v1 offset:40960
    ds_read_b64_tr_b16 v[82:83], v1 offset:43008
    ds_read_b64_tr_b16 v[84:85], v1 offset:45056
    ds_read_b64_tr_b16 v[86:87], v1 offset:47104
    ds_read_b64_tr_b16 v[88:89], v1 offset:49152
    ds_read_b64_tr_b16 v[90:91], v1 offset:51200
    ds_read_b64_tr_b16 v[92:93], v1 offset:53248
    ds_read_b64_tr_b16 v[94:95], v1 offset:55296
    ds_read_b64_tr_b16 v[96:97], v1 offset:57344
    ds_read_b64_tr_b16 v[98:99], v1 offset:59392
    ds_read_b64_tr_b16 v[100:101], v1 offset:61440
    ds_read_b64_tr_b16 v[102:103], v1 offset:63488
    ds_read_b64_tr_b16 v[104:105], v2 offset:0
    ds_read_b64_tr_b16 v[106:107], v2 offset:2048
    ds_read_b64_tr_b16 v[108:109], v2 offset:4096
    ds_read_b64_tr_b16 v[110:111], v2 offset:6144
    ds_read_b64_tr_b16 v[112:113], v2 offset:8192
    ds_read_b64_tr_b16 v[114:115], v2 offset:10240
    ds_read_b64_tr_b16 v[116:117], v2 offset:12288
    ds_read_b64_tr_b16 v[118:119], v2 offset:14336
    ds_read_b64_tr_b16 v[120:121], v2 offset:16384
    ds_read_b64_tr_b16 v[122:123], v2 offset:18432
    ds_read_b64_tr_b16 v[124:125], v2 offset:20480
    ds_read_b64_tr_b16 v[126:127], v2 offset:22528
    ds_read_b64_tr_b16 v[128:129], v2 offset:24576
    ds_read_b64_tr_b16 v[130:131], v2 offset:26624
    ds_read_b64_tr_b16 v[132:133], v2 offset:28672
    ds_read_b64_tr_b16 v[134:135], v2 offset:30720
    ds_read_b64_tr_b16 v[136:137], v2 offset:32768
    ds_read_b64_tr_b16 v[138:139], v2 offset:34816
    ds_read_b64_tr_b16 v[140:141], v2 offset:36864
    ds_read_b64_tr_b16 v[142:143], v2 offset:38912
    ds_read_b64_tr_b16 v[144:145], v2 offset:40960
    ds_read_b64_tr_b16 v[146:147], v2 offset:43008
    ds_read_b64_tr_b16 v[148:149], v2 offset:45056
    ds_read_b64_tr_b16 v[150:151], v2 offset:47104
    ds_read_b64_tr_b16 v[152:153], v2 offset:49152
    ds_read_b64_tr_b16 v[154:155], v2 offset:51200
    ds_read_b64_tr_b16 v[156:157], v2 offset:53248
    ds_read_b64_tr_b16 v[158:159], v2 offset:55296
    ds_read_b64_tr_b16 v[160:161], v2 offset:57344
    ds_read_b64_tr_b16 v[162:163], v2 offset:59392
    ds_read_b64_tr_b16 v[164:165], v2 offset:61440
    ds_read_b64_tr_b16 v[166:167], v2 offset:63488
    s_mov_b64 exec, 1
    ds_add_u32 v5, v7 offset:12
    s_mov_b64 exec, -1
    s_lshl_b32 s60, s5, 1
    s_lshr_b32 s59, s4, 3
    s_add_u32 s60, s60, s59
    s_lshl_b32 s60, s60, 1
    s_and_b32 s59, s4, 1
    s_add_u32 s60, s60, s59
    s_lshl_b32 s60, s60, 16
    s_and_b32 s59, s4, 6
    s_lshl_b32 s59, s59, 7
    s_add_u32 s60, s60, s59
    s_lshl_b32 s59, s3, 6
    s_add_u32 s60, s60, s59
    s_lshl_b32 s63, s5, 8
    s_add_u32 s63, s63, s4
    s_lshl_b32 s63, s63, 7
    s_add_u32 s63, s63, 11534336
    v_lshlrev_b32 v6, 11, v0
    v_mov_b32 v7, s52
    s_mov_b32 s62, 2097152
    s_cmp_lg_u32 s3, 0
    s_waitcnt vmcnt(0) lgkmcnt(0)
    s_barrier
    s_cbranch_scc1 L_nhint
    s_mov_b64 exec, 0xffff
    buffer_store_dword v7, v6, s[16:19], s63 offen sc1
    s_mov_b64 exec, -1
L_nhint:
    s_setprio 0
    v_and_b32 v3, 7, v0
    v_lshl_add_u32 v5, v3, 2, v5
    v_add_u32 v1, 65536, v14
    s_lshl_b32 s53, s3, 6
    s_sub_u32 s60, s60, s53
    s_add_u32 s53, s53, 132096
    v_mul_u32_u24 v2, 272, v10
    v_lshl_add_u32 v2, v8, 5, v2
    v_add_u32 v2, s53, v2
    v_lshrrev_b32 v3, 4, v0
    v_and_b32 v0, 0xf0, v14
    s_lshl_b32 s53, s3, 3
    v_add_u32 v3, s53, v3
    v_lshl_add_u32 v4, v3, 11, v0
    v_mul_u32_u24 v3, 272, v3
    v_add_u32 v0, v0, v3
    v_add_u32 v0, 132096, v0
    s_add_u32 s61, s60, 0x2000
L_gs:
    ds_read_b32 v3, v5 offset:32
    s_sub_u32 s62, s62, 1
L_stub11:
    s_cbranch_execz L_warm
    s_nop 0
    s_cbranch_scc1 L_gs0
    s_waitcnt lgkmcnt(0)
    v_cmp_ne_u32 vcc, 0, v3
    s_and_b32 s53, vcc_lo, 0x11
    s_cbranch_scc0 L_gs
L_gs0:
    s_setprio 3
    s_and_b32 s59, s53, 1
    ds_read_b32 v3, v5 offset:32
    s_cbranch_scc1 L_gs1
    ds_read_b128 v[24:27], v1 offset:16384
    ds_read_b128 v[28:31], v1 offset:17408
    ds_read_b128 v[32:35], v1 offset:18432
    ds_read_b128 v[36:39], v1 offset:19456
    s_branch L_gb4
L_gr0:
    ds_read_b32 v3, v5 offset:32
    s_sub_u32 s62, s62, 1
    s_cbranch_scc1 L_gk0
    s_waitcnt lgkmcnt(0)
    v_cmp_ne_u32 vcc, 0, v3
    s_bitcmp1_b32 vcc_lo, 0
    s_cbranch_scc1 L_gk0
    s_branch L_gr0
L_gr1:
    ds_read_b32 v3, v5 offset:32
    s_sub_u32 s62, s62, 1
    s_cbranch_scc1 L_gk1
    s_waitcnt lgkmcnt(0)
    v_cmp_ne_u32 vcc, 0, v3
    s_bitcmp1_b32 vcc_lo, 1
    s_cbranch_scc1 L_gk1
    s_branch L_gr1
L_gr2:
    ds_read_b32 v3, v5 offset:32
    s_sub_u32 s62, s62, 1
    s_cbranch_scc1 L_gk2
    s_waitcnt lgkmcnt(0)
    v_cmp_ne_u32 vcc, 0, v3
    s_bitcmp1_b32 vcc_lo, 2
    s_cbranch_scc1 L_gk2
    s_branch L_gr2
L_gr3:
    ds_read_b32 v3, v5 offset:32
    s_sub_u32 s62, s62, 1
    s_cbranch_scc1 L_gk3
    s_waitcnt lgkmcnt(0)
    v_cmp_ne_u32 vcc, 0, v3
    s_bitcmp1_b32 vcc_lo, 3
    s_cbranch_scc1 L_gk3
    s_branch L_gr3
L_gr4:
    ds_read_b32 v3, v5 offset:32
    s_sub_u32 s62, s62, 1
    s_cbranch_scc1 L_gk4
    s_waitcnt lgkmcnt(0)
    v_cmp_ne_u32 vcc, 0, v3
    s_bitcmp1_b32 vcc_lo, 4
    s_cbranch_scc1 L_gk4
    s_branch L_gr4
L_gr5:
    ds_read_b32 v3, v5 offset:32
    s_sub_u32 s62, s62, 1
    s_cbranch_scc1 L_gk5
    s_waitcnt lgkmcnt(0)
    v_cmp_ne_u32 vcc, 0, v3
    s_bitcmp1_b32 vcc_lo, 5
    s_cbranch_scc1 L_gk5
    s_branch L_gr5
L_gr6:
    ds_read_b32 v3, v5 offset:32
    s_sub_u32 s62, s62, 1
    s_cbranch_scc1 L_gk6
    s_waitcnt lgkmcnt(0)
    v_cmp_ne_u32 vcc, 0, v3
    s_bitcmp1_b32 vcc_lo, 6
    s_cbranch_scc1 L_gk6
    s_branch L_gr6
L_gr7:
    ds_read_b32 v3, v5 offset:32
    s_sub_u32 s62, s62, 1
    s_cbranch_scc1 L_gk7
    s_waitcnt lgkmcnt(0)
    v_cmp_ne_u32 vcc, 0, v3
    s_bitcmp1_b32 vcc_lo, 7
    s_cbranch_scc1 L_gk7
    s_branch L_gr7
L_gs1:
    ds_read_b128 v[24:27], v1 offset:0
    ds_read_b128 v[28:31], v1 offset:1024
    ds_read_b128 v[32:35], v1 offset:2048
    ds_read_b128 v[36:39], v1 offset:3072
L_gb0:
    s_waitcnt lgkmcnt(3)
    v_cmp_ne_u32 vcc, 0, v3
    v_mfma_f32_32x32x16_bf16 v[8:23], v[40:43], v[24:27], 0
    s_bitcmp1_b32 vcc_lo, 1
    s_cbranch_scc0 L_gr1
L_gk1:
    ds_read_b32 v3, v5 offset:32
    ds_read_b128 v[24:27], v1 offset:4096
    s_waitcnt lgkmcnt(4)
    v_mfma_f32_32x32x16_bf16 v[8:23], v[44:47], v[28:31], v[8:23]
    ds_read_b128 v[28:31], v1 offset:5120
    s_waitcnt lgkmcnt(4)
    v_mfma_f32_32x32x16_bf16 v[8:23], v[48:51], v[32:35], v[8:23]
    ds_read_b128 v[32:35], v1 offset:6144
    s_waitcnt lgkmcnt(4)
    v_mfma_f32_32x32x16_bf16 v[8:23], v[52:55], v[36:39], v[8:23]
    ds_read_b128 v[36:39], v1 offset:7168
L_gb1:
    s_waitcnt lgkmcnt(3)
    v_cmp_ne_u32 vcc, 0, v3
    v_mfma_f32_32x32x16_bf16 v[8:23], v[56:59], v[24:27], v[8:23]
    s_bitcmp1_b32 vcc_lo, 2
    s_cbranch_scc0 L_gr2
L_gk2:
    ds_read_b32 v3, v5 offset:32
    ds_read_b128 v[24:27], v1 offset:8192
    s_waitcnt lgkmcnt(4)
    v_mfma_f32_32x32x16_bf16 v[8:23], v[60:63], v[28:31], v[8:23]
    ds_read_b128 v[28:31], v1 offset:9216
    s_waitcnt lgkmcnt(4)
    v_mfma_f32_32x32x16_bf16 v[8:23], v[64:67], v[32:35], v[8:23]
    ds_read_b128 v[32:35], v1 offset:10240
    s_waitcnt lgkmcnt(4)
    v_mfma_f32_32x32x16_bf16 v[8:23], v[68:71], v[36:39], v[8:23]
    ds_read_b128 v[36:39], v1 offset:11264
L_gb2:
    s_waitcnt lgkmcnt(3)
    v_cmp_ne_u32 vcc, 0, v3
    v_mfma_f32_32x32x16_bf16 v[8:23], v[72:75], v[24:27], v[8:23]
    s_bitcmp1_b32 vcc_lo, 3
    s_cbranch_scc0 L_gr3
L_gk3:
    ds_read_b32 v3, v5 offset:32
    ds_read_b128 v[24:27], v1 offset:12288
    s_waitcnt lgkmcnt(4)
    v_mfma_f32_32x32x16_bf16 v[8:23], v[76:79], v[28:31], v[8:23]
    ds_read_b128 v[28:31], v1 offset:13312
    s_waitcnt lgkmcnt(4)
    v_mfma_f32_32x32x16_bf16 v[8:23], v[80:83], v[32:35], v[8:23]
    ds_read_b128 v[32:35], v1 offset:14336
    s_waitcnt lgkmcnt(4)
    v_mfma_f32_32x32x16_bf16 v[8:23], v[84:87], v[36:39], v[8:23]
    ds_read_b128 v[36:39], v1 offset:15360
L_gb3:
    s_waitcnt lgkmcnt(3)
    v_cmp_ne_u32 vcc, 0, v3
    v_mfma_f32_32x32x16_bf16 v[8:23], v[88:91], v[24:27], v[8:23]
    s_bitcmp1_b32 vcc_lo, 4
    s_cbranch_scc0 L_gr4
L_gk4:
    ds_read_b32 v3, v5 offset:32
    ds_read_b128 v[24:27], v1 offset:16384
    s_waitcnt lgkmcnt(4)
    v_mfma_f32_32x32x16_bf16 v[8:23], v[92:95], v[28:31], v[8:23]
    ds_read_b128 v[28:31], v1 offset:17408
    s_waitcnt lgkmcnt(4)
    v_mfma_f32_32x32x16_bf16 v[8:23], v[96:99], v[32:35], v[8:23]
    ds_read_b128 v[32:35], v1 offset:18432
    s_waitcnt lgkmcnt(4)
    v_mfma_f32_32x32x16_bf16 v[40:55], v[100:103], v[36:39], v[8:23]
    ds_read_b128 v[36:39], v1 offset:19456
    s_cmp_eq_u32 s59, 0
    s_cbranch_scc1 L_gx
L_gb4:
    s_waitcnt lgkmcnt(3)
    v_cmp_ne_u32 vcc, 0, v3
    v_mfma_f32_32x32x16_bf16 v[8:23], v[104:107], v[24:27], 0
    s_bitcmp1_b32 vcc_lo, 5
    s_cbranch_scc0 L_gr5
L_gk5:
    ds_read_b32 v3, v5 offset:32
    ds_read_b128 v[24:27], v1 offset:20480
    s_waitcnt lgkmcnt(4)
    v_mfma_f32_32x32x16_bf16 v[8:23], v[108:111], v[28:31], v[8:23]
    ds_read_b128 v[28:31], v1 offset:21504
    s_waitcnt lgkmcnt(4)
    v_mfma_f32_32x32x16_bf16 v[8:23], v[112:115], v[32:35], v[8:23]
    ds_read_b128 v[32:35], v1 offset:22528
    s_waitcnt lgkmcnt(4)
    v_mfma_f32_32x32x16_bf16 v[8:23], v[116:119], v[36:39], v[8:23]
    ds_read_b128 v[36:39], v1 offset:23552
L_gb5:
    s_waitcnt lgkmcnt(3)
    v_cmp_ne_u32 vcc, 0, v3
    v_mfma_f32_32x32x16_bf16 v[8:23], v[120:123], v[24:27], v[8:23]
    s_bitcmp1_b32 vcc_lo, 6
    s_cbranch_scc0 L_gr6
L_gk6:
    ds_read_b32 v3, v5 offset:32
    ds_read_b128 v[24:27], v1 offset:24576
    s_waitcnt lgkmcnt(4)
    v_mfma_f32_32x32x16_bf16 v[8:23], v[124:127], v[28:31], v[8:23]
    ds_read_b128 v[28:31], v1 offset:25600
    s_waitcnt lgkmcnt(4)
    v_mfma_f32_32x32x16_bf16 v[8:23], v[128:131], v[32:35], v[8:23]
    ds_read_b128 v[32:35], v1 offset:26624
    s_waitcnt lgkmcnt(4)
    v_mfma_f32_32x32x16_bf16 v[8:23], v[132:135], v[36:39], v[8:23]
    ds_read_b128 v[36:39], v1 offset:27648
L_gb6:
    s_waitcnt lgkmcnt(3)
    v_cmp_ne_u32 vcc, 0, v3
    v_mfma_f32_32x32x16_bf16 v[8:23], v[136:139], v[24:27], v[8:23]
L_stub0:
    s_cbranch_execz L_warm
    s_nop 0
    s_bitcmp1_b32 vcc_lo, 7
    s_cbranch_scc0 L_gr7
L_gk7:
    ds_read_b32 v3, v5 offset:32
    ds_read_b128 v[24:27], v1 offset:28672
    s_waitcnt lgkmcnt(4)
    v_mfma_f32_32x32x16_bf16 v[8:23], v[140:143], v[28:31], v[8:23]
    ds_read_b128 v[28:31], v1 offset:29696
    s_waitcnt lgkmcnt(4)
    v_mfma_f32_32x32x16_bf16 v[8:23], v[144:147], v[32:35], v[8:23]
    ds_read_b128 v[32:35], v1 offset:30720
    s_waitcnt lgkmcnt(4)
    v_mfma_f32_32x32x16_bf16 v[8:23], v[148:151], v[36:39], v[8:23]
    ds_read_b128 v[36:39], v1 offset:31744
L_gb7:
    s_waitcnt lgkmcnt(3)
    v_cmp_ne_u32 vcc, 0, v3
    v_mfma_f32_32x32x16_bf16 v[8:23], v[152:155], v[24:27], v[8:23]
    s_bitcmp1_b32 vcc_lo, 0
    s_cbranch_scc0 L_gr0
L_gk0:
    ds_read_b32 v3, v5 offset:32
    ds_read_b128 v[24:27], v1 offset:0
    s_waitcnt lgkmcnt(4)
    v_mfma_f32_32x32x16_bf16 v[8:23], v[156:159], v[28:31], v[8:23]
    ds_read_b128 v[28:31], v1 offset:1024
    s_waitcnt lgkmcnt(4)
    v_mfma_f32_32x32x16_bf16 v[8:23], v[160:163], v[32:35], v[8:23]
    ds_read_b128 v[32:35], v1 offset:2048
    s_waitcnt lgkmcnt(4)
    v_mfma_f32_32x32x16_bf16 v[104:119], v[164:167], v[36:39], v[8:23]
    ds_read_b128 v[36:39], v1 offset:3072
    s_cmp_eq_u32 s59, 0
    s_cbranch_scc1 L_gb0
L_gx:
    s_nop 8
    v_pk_add_f32 v[8:9], v[40:41], v[104:105]
    v_pk_add_f32 v[10:11], v[42:43], v[106:107]
    v_pk_add_f32 v[12:13], v[44:45], v[108:109]
    v_pk_add_f32 v[14:15], v[46:47], v[110:111]
    v_pk_add_f32 v[16:17], v[48:49], v[112:113]
    v_pk_add_f32 v[18:19], v[50:51], v[114:115]
    v_pk_add_f32 v[20:21], v[52:53], v[116:117]
    v_pk_add_f32 v[22:23], v[54:55], v[118:119]
    v_cvt_pk_bf16_f32 v40, v8, v9
    v_cvt_pk_bf16_f32 v41, v10, v11
    v_cvt_pk_bf16_f32 v42, v12, v13
    v_cvt_pk_bf16_f32 v43, v14, v15
    v_cvt_pk_bf16_f32 v44, v16, v17
    v_cvt_pk_bf16_f32 v45, v18, v19
    v_cvt_pk_bf16_f32 v46, v20, v21
    v_cvt_pk_bf16_f32 v47, v22, v23
    ds_write_b128 v2, v[40:43]
    ds_write_b128 v2, v[44:47] offset:16
    s_waitcnt lgkmcnt(0)
    s_barrier
    ds_read_b128 v[48:51], v0
    ds_read_b128 v[52:55], v0 offset:1088
    s_waitcnt lgkmcnt(1)
    buffer_store_dwordx4 v[48:51], v4, s[20:23], s60 offen sc1
    s_waitcnt lgkmcnt(0)
    buffer_store_dwordx4 v[52:55], v4, s[20:23], s61 offen sc1
    s_or_b32 s53, s2, s3
    s_cbranch_scc1 L_bend
    v_mov_b32 v2, 10682368
    s_mov_b64 exec, 1
    buffer_store_dword v7, v2, s[16:19], 0 offen sc1
    s_mov_b64 exec, -1
L_bend:
L_end:
    s_endpgm
L_G:
    s_setprio 2
    s_and_b32 s57, s54, 3
    v_mov_b64 v[16:17], 0
    v_mov_b64 v[18:19], 0
    v_mov_b64 v[20:21], 0
    v_mov_b64 v[22:23], 0
    v_mov_b64 v[24:25], 0
    v_mov_b64 v[26:27], 0
    v_mov_b64 v[28:29], 0
    v_mov_b64 v[30:31], 0
    v_mov_b64 v[32:33], 0
    v_mov_b64 v[34:35], 0
    v_mov_b64 v[36:37], 0
    v_mov_b64 v[38:39], 0
    v_mov_b64 v[40:41], 0
    v_mov_b64 v[42:43], 0
    v_mov_b64 v[44:45], 0
    v_mov_b64 v[46:47], 0
    v_mov_b64 v[84:85], 0
    v_mov_b64 v[86:87], 0
    v_mov_b64 v[88:89], 0
    v_mov_b64 v[90:91], 0
    v_mov_b64 v[92:93], 0
    v_mov_b64 v[94:95], 0
    v_and_b32 v1, 31, v0
    v_lshrrev_b32 v2, 5, v0
    v_bfe_u32 v3, v1, 1, 3
    v_xor_b32 v3, v3, v2
    v_lshlrev_b32 v3, 4, v3
    v_lshl_add_u32 v3, v1, 7, v3
    s_lshl_b32 s53, s57, 12
    v_add_u32 v8, s53, v3
    v_xor_b32 v9, 32, v8
    v_xor_b32 v10, 64, v8
    v_xor_b32 v11, 0x60, v8
    v_and_b32 v3, 16, v0
    v_and_b32 v4, 3, v0
    v_lshlrev_b32 v4, 3, v4
    v_lshl_add_u32 v4, v3, 1, v4
    v_add_u32 v4, 131072, v4
    v_bfe_u32 v3, v0, 2, 2
    v_lshl_add_u32 v5, v2, 3, v3
    v_lshl_add_u32 v12, v5, 7, v4
    v_lshrrev_b32 v3, 1, v3
    v_lshl_add_u32 v12, v3, 6, v12
    v_xor_b32 v13, 64, v12
    s_lshr_b32 s53, s4, 1
    s_lshl_b32 s61, s53, 19
    s_and_b32 s53, s5, 12
    s_add_u32 s53, s53, s57
    s_lshl_b32 s53, s53, 2
    s_and_b32 s59, s5, 3
    s_add_u32 s53, s53, s59
    s_lshl_b32 s53, s53, 11
    s_add_u32 s61, s61, s53
    s_mov_b32 s59, 0
    s_movk_i32 s60, 0x2000
    s_movk_i32 s58, 0x4000
    s_waitcnt lgkmcnt(0)
    s_add_u32 s66, s16, 10682368
    s_addc_u32 s67, s17, 0
    s_load_dword s52, s[66:67], 0
    s_load_dwordx2 s[24:25], s[0:1], 72
    s_add_u32 s63, s61, 0x40000
    s_bitcmp1_b32 s4, 0
    s_cbranch_scc1 L_v0
    v_and_b32 v7, 0x330, v14
    v_and_b32 v3, 4, v0
    v_lshl_add_u32 v7, v3, 5, v7
    v_and_b32 v3, 8, v0
    v_lshl_add_u32 v7, v3, 3, v7
    s_mov_b32 s56, 0x20000
.p2align 3
L_gk:
    s_barrier
    s_add_u32 s59, s59, 1
    ds_read_b128 v[48:51], v8
    ds_read_b64_tr_b16 v[52:53], v12 offset:0
    ds_read_b64_tr_b16 v[54:55], v12 offset:512
    ds_read_b64_tr_b16 v[56:57], v13 offset:0
    ds_read_b64_tr_b16 v[58:59], v13 offset:512
    v_mfma_f32_32x32x16_bf16 v[16:31], v[88:91], v[84:87], v[16:31]
    ds_read_b128 v[60:63], v9
    ds_read_b64_tr_b16 v[64:65], v12 offset:2048
    ds_read_b64_tr_b16 v[66:67], v12 offset:2560
    v_mfma_f32_32x32x16_bf16 v[32:47], v[92:95], v[84:87], v[32:47]
    ds_read_b64_tr_b16 v[68:69], v13 offset:2048
    ds_read_b64_tr_b16 v[70:71], v13 offset:2560
    ds_read_b128 v[72:75], v10
    ds_read_b64_tr_b16 v[76:77], v12 offset:4096
    ds_read_b64_tr_b16 v[78:79], v12 offset:4608
    ds_read_b64_tr_b16 v[80:81], v13 offset:4096
    ds_read_b64_tr_b16 v[82:83], v13 offset:4608
    s_waitcnt lgkmcnt(10)
    s_cmp_eq_u32 s59, 4
    v_mfma_f32_32x32x16_bf16 v[16:31], v[52:55], v[48:51], v[16:31]
    ds_read_b128 v[84:87], v11
    ds_read_b64_tr_b16 v[88:89], v12 offset:6144
    ds_read_b64_tr_b16 v[90:91], v12 offset:6656
    v_mfma_f32_32x32x16_bf16 v[32:47], v[56:59], v[48:51], v[32:47]
    ds_read_b64_tr_b16 v[92:93], v13 offset:6144
    ds_read_b64_tr_b16 v[94:95], v13 offset:6656
    s_cselect_b32 s53, 0xffffa000, s60
    s_waitcnt lgkmcnt(10)
    s_cmp_lt_u32 s59, 8
    v_mfma_f32_32x32x16_bf16 v[16:31], v[64:67], v[60:63], v[16:31]
L_stub1:
    s_cbranch_execz L_warm
    s_nop 0
    v_add_u32 v8, s58, v8
    v_add_u32 v9, s58, v9
    v_mfma_f32_32x32x16_bf16 v[32:47], v[68:71], v[60:63], v[32:47]
    v_add_u32 v10, s58, v10
    s_waitcnt lgkmcnt(5)
    v_mfma_f32_32x32x16_bf16 v[16:31], v[76:79], v[72:75], v[16:31]
    v_add_u32 v11, s58, v11
    v_add_u32 v12, s53, v12
    v_mfma_f32_32x32x16_bf16 v[32:47], v[80:83], v[72:75], v[32:47]
    v_add_u32 v13, s53, v13
    s_waitcnt lgkmcnt(0)
    s_cbranch_scc1 L_gk
    v_mfma_f32_32x32x16_bf16 v[16:31], v[88:91], v[84:87], v[16:31]
    v_mfma_f32_32x32x16_bf16 v[32:47], v[92:95], v[84:87], v[32:47]
    s_branch L_ge
L_v0:
    v_and_b32 v7, 0xf0, v14
    v_lshl_add_u32 v7, v2, 8, v7
    v_and_b32 v3, 16, v0
    v_lshl_add_u32 v7, v3, 13, v7
    v_add_u32 v7, 0x400, v7
    s_movk_i32 s56, 0x200
.p2align 3
L_gv:
    s_barrier
    s_add_u32 s59, s59, 1
    ds_read_b128 v[48:51], v8
    ds_read_b64_tr_b16 v[52:53], v12 offset:0
    ds_read_b64_tr_b16 v[54:55], v12 offset:512
    ds_read_b64_tr_b16 v[56:57], v13 offset:0
    ds_read_b64_tr_b16 v[58:59], v13 offset:512
    v_mfma_f32_32x32x16_bf16 v[16:31], v[84:87], v[88:91], v[16:31]
    ds_read_b128 v[60:63], v9
    ds_read_b64_tr_b16 v[64:65], v12 offset:2048
    ds_read_b64_tr_b16 v[66:67], v12 offset:2560
    v_mfma_f32_32x32x16_bf16 v[32:47], v[84:87], v[92:95], v[32:47]
    ds_read_b64_tr_b16 v[68:69], v13 offset:2048
    ds_read_b64_tr_b16 v[70:71], v13 offset:2560
    ds_read_b128 v[72:75], v10
    ds_read_b64_tr_b16 v[76:77], v12 offset:4096
    ds_read_b64_tr_b16 v[78:79], v12 offset:4608
    ds_read_b64_tr_b16 v[80:81], v13 offset:4096
    ds_read_b64_tr_b16 v[82:83], v13 offset:4608
    s_waitcnt lgkmcnt(10)
    s_cmp_eq_u32 s59, 4
    v_mfma_f32_32x32x16_bf16 v[16:31], v[48:51], v[52:55], v[16:31]
    ds_read_b128 v[84:87], v11
    ds_read_b64_tr_b16 v[88:89], v12 offset:6144
    ds_read_b64_tr_b16 v[90:91], v12 offset:6656
    v_mfma_f32_32x32x16_bf16 v[32:47], v[48:51], v[56:59], v[32:47]
    ds_read_b64_tr_b16 v[92:93], v13 offset:6144
    ds_read_b64_tr_b16 v[94:95], v13 offset:6656
    s_cselect_b32 s53, 0xffffa000, s60
    s_waitcnt lgkmcnt(10)
    s_cmp_lt_u32 s59, 8
    v_mfma_f32_32x32x16_bf16 v[16:31], v[60:63], v[64:67], v[16:31]
    v_add_u32 v8, s58, v8
    v_add_u32 v9, s58, v9
    v_mfma_f32_32x32x16_bf16 v[32:47], v[60:63], v[68:71], v[32:47]
    v_add_u32 v10, s58, v10
    s_waitcnt lgkmcnt(5)
    v_mfma_f32_32x32x16_bf16 v[16:31], v[72:75], v[76:79], v[16:31]
    v_add_u32 v11, s58, v11
    v_add_u32 v12, s53, v12
    v_mfma_f32_32x32x16_bf16 v[32:47], v[72:75], v[80:83], v[32:47]
    v_add_u32 v13, s53, v13
    s_waitcnt lgkmcnt(0)
    s_cbranch_scc1 L_gv
    v_mfma_f32_32x32x16_bf16 v[16:31], v[84:87], v[88:91], v[16:31]
    v_mfma_f32_32x32x16_bf16 v[32:47], v[84:87], v[92:95], v[32:47]
L_ge:
    s_mov_b32 s44, s61
    s_add_u32 s45, s61, s56
    s_mov_b32 s46, s63
    s_add_u32 s47, s63, s56
    s_mul_i32 s52, s52, 1664525
    s_add_u32 s52, s52, 1013904223
    s_cmp_lg_u32 s57, 0
    s_nop 3
    v_cvt_pk_bf16_f32 v152, v16, v17
    v_cvt_pk_bf16_f32 v153, v18, v19
    v_cvt_pk_bf16_f32 v154, v20, v21
    v_cvt_pk_bf16_f32 v155, v22, v23
    v_cvt_pk_bf16_f32 v156, v24, v25
    v_cvt_pk_bf16_f32 v157, v26, v27
    v_cvt_pk_bf16_f32 v158, v28, v29
    v_cvt_pk_bf16_f32 v159, v30, v31
    v_cvt_pk_bf16_f32 v160, v32, v33
    v_cvt_pk_bf16_f32 v161, v34, v35
    v_cvt_pk_bf16_f32 v162, v36, v37
    v_cvt_pk_bf16_f32 v163, v38, v39
    v_cvt_pk_bf16_f32 v164, v40, v41
    v_cvt_pk_bf16_f32 v165, v42, v43
    v_cvt_pk_bf16_f32 v166, v44, v45
    v_cvt_pk_bf16_f32 v167, v46, v47
    s_cbranch_scc1 L_b8
    buffer_store_dwordx4 v[152:155], v7, s[16:19], s44 offen sc1
    buffer_store_dwordx4 v[156:159], v7, s[16:19], s45 offen sc1
    buffer_store_dwordx4 v[160:163], v7, s[16:19], s46 offen sc1
    buffer_store_dwordx4 v[164:167], v7, s[16:19], s47 offen sc1
    s_branch L_b8
L_P:
    s_waitcnt lgkmcnt(0)
    s_add_u32 s58, s16, 10682368
    s_addc_u32 s59, s17, 0
    s_load_dword s52, s[58:59], 0
    s_load_dwordx2 s[24:25], s[0:1], 72
    s_lshl_b32 s69, s4, 4
    s_add_u32 s69, s69, s5
    s_lshl_b32 s69, s69, 7
    s_lshl_b32 s59, s54, 15
    s_add_u32 s69, s69, s59
    s_add_u32 s69, s69, 10485760
    s_lshl_b32 s53, s6, 5
    s_add_u32 s53, s53, s7
    s_lshl_b32 s53, s53, 7
    s_and_b32 s59, s59, 0x8000
    s_add_u32 s53, s53, s59
    s_add_u32 s57, s53, 10616832
    v_and_b32 v1, 31, v0
    v_lshrrev_b32 v2, 5, v0
    v_bfe_u32 v3, v1, 1, 3
    v_xor_b32 v3, v3, v2
    v_lshlrev_b32 v3, 4, v3
    v_lshl_add_u32 v3, v1, 7, v3
    s_lshl_b32 s53, s54, 12
    v_add_u32 v8, s53, v3
    v_xor_b32 v9, 32, v8
    v_xor_b32 v10, 64, v8
    v_xor_b32 v11, 0x60, v8
    v_add_u32 v7, s53, v14
    v_and_b32 v3, 16, v0
    v_and_b32 v4, 3, v0
    v_lshlrev_b32 v4, 3, v4
    v_lshl_add_u32 v4, v3, 1, v4
    v_add_u32 v4, 36864, v4
    v_bfe_u32 v3, v0, 2, 2
    v_lshl_add_u32 v5, v2, 3, v3
    v_lshl_add_u32 v15, v5, 6, v4
    s_barrier
    ds_read_b128 v[16:19], v8 offset:0
    ds_read_b128 v[20:23], v9 offset:0
    ds_read_b128 v[24:27], v10 offset:0
    ds_read_b128 v[28:31], v11 offset:0
    s_barrier
    ds_read_b128 v[32:35], v8 offset:16384
    ds_read_b128 v[36:39], v9 offset:16384
    ds_read_b128 v[40:43], v10 offset:16384
    ds_read_b128 v[44:47], v11 offset:16384
    s_barrier
    ds_read_b128 v[48:51], v8 offset:32768
    ds_read_b128 v[52:55], v9 offset:32768
    ds_read_b128 v[56:59], v10 offset:32768
    ds_read_b128 v[60:63], v11 offset:32768
    s_barrier
    ds_read_b128 v[64:67], v8 offset:49152
    ds_read_b128 v[68:71], v9 offset:49152
    ds_read_b128 v[72:75], v10 offset:49152
    ds_read_b128 v[76:79], v11 offset:49152
    s_barrier
    v_add_u32 v8, 0x10000, v8
    v_add_u32 v9, 0x10000, v9
    v_add_u32 v10, 0x10000, v10
    v_add_u32 v11, 0x10000, v11
L_stub2:
    s_cbranch_execz L_warm
    s_nop 0
    ds_read_b128 v[80:83], v8 offset:0
    ds_read_b128 v[84:87], v9 offset:0
    ds_read_b128 v[88:91], v10 offset:0
    ds_read_b128 v[92:95], v11 offset:0
    s_barrier
    s_waitcnt lgkmcnt(0)
    s_barrier
    buffer_load_dword v6, off, s[16:19], s69 sc1
    buffer_load_dword v6, off, s[16:19], s57 sc1
    s_mul_i32 s52, s52, 1664525
    s_add_u32 s52, s52, 1013904223
    s_barrier
L_b8:
    s_barrier
    s_and_b32 s58, s54, 1
    s_lshr_b32 s55, s54, 1
    s_lshl_b32 s63, s5, 2
    s_add_u32 s63, s63, s55
    s_lshl_b32 s63, s63, 4
    s_add_u32 s63, s63, s4
    s_lshl_b32 s63, s63, 1
    s_add_u32 s63, s63, s58
    s_lshl_b32 s63, s63, 10
    s_add_u32 s63, s63, 4194304
    s_lshl_b32 s53, s55, 2
    s_add_u32 s53, s53, s58
    s_lshl_b32 s53, s53, 10
    v_add_u32 v1, s53, v14
    v_and_b32 v4, 0xf0, v14
    v_lshrrev_b32 v3, 5, v0
    v_lshl_add_u32 v4, v3, 8, v4
    v_mov_b32 v2, 0xdddddddd
    s_mov_b32 s64, 0xffff
    s_mov_b32 s65, s64
    s_mov_b32 s66, 0x3f803f80
    s_mov_b32 s67, s66
    s_lshl_b32 s68, s4, 1
    s_add_u32 s68, s68, s58
    s_lshl_b32 s68, s68, 17
    s_lshl_b32 s60, s55, 15
    s_add_u32 s60, s60, s68
    s_mov_b64 s[20:21], s[16:17]
    s_add_u32 s22, s60, 0x8000
    s_mov_b32 s23, s11
    s_mov_b32 s26, 0x400000
    s_mov_b32 s27, s11
    s_bfe_u32 s53, s7, 0x10003
    s_lshl_b32 s59, s53, 10
    s_and_b32 s53, s7, 1
    s_lshl_b32 s53, s53, 8
    s_add_u32 s59, s59, s53
    s_and_b32 s53, s7, 16
    s_add_u32 s59, s59, s53
    s_and_b32 s53, s7, 6
    s_lshl_b32 s53, s53, 1
    s_add_u32 s59, s59, s53
    s_lshl_b32 s53, s54, 5
    s_add_u32 s59, s59, s53
    s_lshl_b32 s59, s59, 4
    s_add_u32 s59, s59, s6
    s_lshl_b32 s49, s59, 7
    v_mov_b64 v[12:13], 0
    s_mov_b32 exec_lo, 0x110000
    s_mov_b32 exec_hi, exec_lo
    v_mov_b64 v[12:13], s[66:67]
    s_mov_b64 exec, -1
    s_cmp_ge_u32 s54, 4
    s_cbranch_scc1 L_gf
    ds_read_b128 v[96:99], v8 offset:16384
    ds_read_b128 v[100:103], v9 offset:16384
    ds_read_b128 v[104:107], v10 offset:16384
    ds_read_b128 v[108:111], v11 offset:16384
    ds_read_b128 v[112:115], v8 offset:32768
    ds_read_b128 v[116:119], v9 offset:32768
    ds_read_b128 v[120:123], v10 offset:32768
    ds_read_b128 v[124:127], v11 offset:32768
    ds_read_b128 v[160:163], v8 offset:49152
    ds_read_b128 v[164:167], v9 offset:49152
    s_mov_b32 s66, 1052289595
    s_mov_b32 s67, s66
    s_waitcnt lgkmcnt(0)
    s_barrier
    ds_read_b64_tr_b16 v[128:129], v15 offset:0
    ds_read_b64_tr_b16 v[130:131], v15 offset:256
    ds_read_b64_tr_b16 v[132:133], v15 offset:1024
    ds_read_b64_tr_b16 v[134:135], v15 offset:1280
    ds_read_b64_tr_b16 v[136:137], v15 offset:2048
    ds_read_b64_tr_b16 v[138:139], v15 offset:2304
    ds_read_b64_tr_b16 v[140:141], v15 offset:3072
    ds_read_b64_tr_b16 v[142:143], v15 offset:3328
    s_waitcnt lgkmcnt(6)
    v_mfma_f32_32x32x16_bf16 v[144:159], v[128:131], v[16:19], 0
    ds_read_b64_tr_b16 v[128:129], v15 offset:4096
    ds_read_b64_tr_b16 v[130:131], v15 offset:4352
    ds_read_b128 v[16:19], v10 offset:49152
    s_waitcnt lgkmcnt(7)
    v_mfma_f32_32x32x16_bf16 v[144:159], v[132:135], v[20:23], v[144:159]
    ds_read_b64_tr_b16 v[132:133], v15 offset:5120
    ds_read_b64_tr_b16 v[134:135], v15 offset:5376
    ds_read_b128 v[20:23], v11 offset:49152
    s_waitcnt lgkmcnt(8)
    v_mfma_f32_32x32x16_bf16 v[144:159], v[136:139], v[24:27], v[144:159]
    ds_read_b64_tr_b16 v[136:137], v15 offset:6144
    ds_read_b64_tr_b16 v[138:139], v15 offset:6400
    s_waitcnt lgkmcnt(8)
    v_mfma_f32_32x32x16_bf16 v[144:159], v[140:143], v[28:31], v[144:159]
    ds_read_b64_tr_b16 v[140:141], v15 offset:7168
    ds_read_b64_tr_b16 v[142:143], v15 offset:7424
    s_waitcnt lgkmcnt(8)
    v_mfma_f32_32x32x16_bf16 v[144:159], v[128:131], v[32:35], v[144:159]
    ds_read_b64_tr_b16 v[128:129], v15 offset:8192
    ds_read_b64_tr_b16 v[130:131], v15 offset:8448
    s_waitcnt lgkmcnt(7)
    v_mfma_f32_32x32x16_bf16 v[144:159], v[132:135], v[36:39], v[144:159]
    ds_read_b64_tr_b16 v[132:133], v15 offset:9216
    ds_read_b64_tr_b16 v[134:135], v15 offset:9472
    s_waitcnt lgkmcnt(6)
    v_mfma_f32_32x32x16_bf16 v[144:159], v[136:139], v[40:43], v[144:159]
    ds_read_b64_tr_b16 v[136:137], v15 offset:10240
    ds_read_b64_tr_b16 v[138:139], v15 offset:10496
    s_waitcnt lgkmcnt(6)
    v_mfma_f32_32x32x16_bf16 v[144:159], v[140:143], v[44:47], v[144:159]
    ds_read_b64_tr_b16 v[140:141], v15 offset:11264
    ds_read_b64_tr_b16 v[142:143], v15 offset:11520
    s_waitcnt lgkmcnt(6)
    v_mfma_f32_32x32x16_bf16 v[144:159], v[128:131], v[48:51], v[144:159]
    ds_read_b64_tr_b16 v[128:129], v15 offset:12288
    ds_read_b64_tr_b16 v[130:131], v15 offset:12544
    s_waitcnt lgkmcnt(6)
    v_mfma_f32_32x32x16_bf16 v[144:159], v[132:135], v[52:55], v[144:159]
    ds_read_b64_tr_b16 v[132:133], v15 offset:13312
    ds_read_b64_tr_b16 v[134:135], v15 offset:13568
    s_waitcnt lgkmcnt(6)
    v_mfma_f32_32x32x16_bf16 v[144:159], v[136:139], v[56:59], v[144:159]
    ds_read_b64_tr_b16 v[136:137], v15 offset:14336
    ds_read_b64_tr_b16 v[138:139], v15 offset:14592
    s_waitcnt lgkmcnt(6)
    v_mfma_f32_32x32x16_bf16 v[144:159], v[140:143], v[60:63], v[144:159]
    ds_read_b64_tr_b16 v[140:141], v15 offset:15360
    ds_read_b64_tr_b16 v[142:143], v15 offset:15616
    s_waitcnt lgkmcnt(6)
    v_mfma_f32_32x32x16_bf16 v[144:159], v[128:131], v[64:67], v[144:159]
    ds_read_b64_tr_b16 v[128:129], v15 offset:16384
    ds_read_b64_tr_b16 v[130:131], v15 offset:16640
    s_waitcnt lgkmcnt(6)
    v_mfma_f32_32x32x16_bf16 v[144:159], v[132:135], v[68:71], v[144:159]
    ds_read_b64_tr_b16 v[132:133], v15 offset:17408
    ds_read_b64_tr_b16 v[134:135], v15 offset:17664
    s_waitcnt lgkmcnt(6)
    v_mfma_f32_32x32x16_bf16 v[144:159], v[136:139], v[72:75], v[144:159]
    ds_read_b64_tr_b16 v[136:137], v15 offset:18432
    ds_read_b64_tr_b16 v[138:139], v15 offset:18688
    s_waitcnt lgkmcnt(6)
    v_mfma_f32_32x32x16_bf16 v[144:159], v[140:143], v[76:79], v[144:159]
    ds_read_b64_tr_b16 v[140:141], v15 offset:19456
    ds_read_b64_tr_b16 v[142:143], v15 offset:19712
    s_waitcnt lgkmcnt(6)
    v_mfma_f32_32x32x16_bf16 v[144:159], v[128:131], v[80:83], v[144:159]
    ds_read_b64_tr_b16 v[128:129], v15 offset:20480
    ds_read_b64_tr_b16 v[130:131], v15 offset:20736
    s_waitcnt lgkmcnt(6)
    v_mfma_f32_32x32x16_bf16 v[144:159], v[132:135], v[84:87], v[144:159]
    ds_read_b64_tr_b16 v[132:133], v15 offset:21504
L_stub3:
    s_cbranch_execz L_warm
    s_nop 0
    ds_read_b64_tr_b16 v[134:135], v15 offset:21760
    s_waitcnt lgkmcnt(6)
    v_mfma_f32_32x32x16_bf16 v[144:159], v[136:139], v[88:91], v[144:159]
    ds_read_b64_tr_b16 v[136:137], v15 offset:22528
    ds_read_b64_tr_b16 v[138:139], v15 offset:22784
    s_waitcnt lgkmcnt(6)
    v_mfma_f32_32x32x16_bf16 v[144:159], v[140:143], v[92:95], v[144:159]
    ds_read_b64_tr_b16 v[140:141], v15 offset:23552
    ds_read_b64_tr_b16 v[142:143], v15 offset:23808
    s_waitcnt lgkmcnt(6)
    v_mfma_f32_32x32x16_bf16 v[144:159], v[128:131], v[96:99], v[144:159]
    ds_read_b64_tr_b16 v[128:129], v15 offset:24576
    ds_read_b64_tr_b16 v[130:131], v15 offset:24832
    s_waitcnt lgkmcnt(6)
    v_mfma_f32_32x32x16_bf16 v[144:159], v[132:135], v[100:103], v[144:159]
    ds_read_b64_tr_b16 v[132:133], v15 offset:25600
    ds_read_b64_tr_b16 v[134:135], v15 offset:25856
    s_waitcnt lgkmcnt(6)
    v_mfma_f32_32x32x16_bf16 v[144:159], v[136:139], v[104:107], v[144:159]
    ds_read_b64_tr_b16 v[136:137], v15 offset:26624
    ds_read_b64_tr_b16 v[138:139], v15 offset:26880
    s_waitcnt lgkmcnt(6)
    v_mfma_f32_32x32x16_bf16 v[144:159], v[140:143], v[108:111], v[144:159]
    ds_read_b64_tr_b16 v[140:141], v15 offset:27648
    ds_read_b64_tr_b16 v[142:143], v15 offset:27904
    s_waitcnt lgkmcnt(6)
    v_mfma_f32_32x32x16_bf16 v[144:159], v[128:131], v[112:115], v[144:159]
    ds_read_b64_tr_b16 v[128:129], v15 offset:28672
    ds_read_b64_tr_b16 v[130:131], v15 offset:28928
    s_waitcnt lgkmcnt(6)
    v_mfma_f32_32x32x16_bf16 v[144:159], v[132:135], v[116:119], v[144:159]
    ds_read_b64_tr_b16 v[132:133], v15 offset:29696
    ds_read_b64_tr_b16 v[134:135], v15 offset:29952
    s_waitcnt lgkmcnt(6)
    v_mfma_f32_32x32x16_bf16 v[144:159], v[136:139], v[120:123], v[144:159]
    ds_read_b64_tr_b16 v[136:137], v15 offset:30720
    ds_read_b64_tr_b16 v[138:139], v15 offset:30976
    s_waitcnt lgkmcnt(6)
    v_mfma_f32_32x32x16_bf16 v[144:159], v[140:143], v[124:127], v[144:159]
    ds_read_b64_tr_b16 v[140:141], v15 offset:31744
    ds_read_b64_tr_b16 v[142:143], v15 offset:32000
    s_waitcnt lgkmcnt(6)
    v_mfma_f32_32x32x16_bf16 v[144:159], v[128:131], v[160:163], v[144:159]
    s_waitcnt lgkmcnt(4)
    v_mfma_f32_32x32x16_bf16 v[144:159], v[132:135], v[164:167], v[144:159]
    s_waitcnt lgkmcnt(2)
    v_mfma_f32_32x32x16_bf16 v[144:159], v[136:139], v[16:19], v[144:159]
    s_waitcnt lgkmcnt(0)
    v_mfma_f32_32x32x16_bf16 v[144:159], v[140:143], v[20:23], v[144:159]
    s_nop 11
    v_pk_mul_f32 v[144:145], v[144:145], s[66:67]
    v_pk_mul_f32 v[146:147], v[146:147], s[66:67]
    v_pk_mul_f32 v[148:149], v[148:149], s[66:67]
    v_pk_mul_f32 v[150:151], v[150:151], s[66:67]
    v_pk_mul_f32 v[152:153], v[152:153], s[66:67]
    v_pk_mul_f32 v[154:155], v[154:155], s[66:67]
    v_pk_mul_f32 v[156:157], v[156:157], s[66:67]
    v_pk_mul_f32 v[158:159], v[158:159], s[66:67]
    v_cvt_pk_bf16_f32 v96, v144, v145
    v_cvt_pk_bf16_f32 v97, v146, v147
    v_cvt_pk_bf16_f32 v98, v148, v149
    v_cvt_pk_bf16_f32 v99, v150, v151
    v_cvt_pk_bf16_f32 v100, v152, v153
    v_cvt_pk_bf16_f32 v101, v154, v155
    v_cvt_pk_bf16_f32 v102, v156, v157
    v_cvt_pk_bf16_f32 v103, v158, v159
    ds_write_b128 v7, v[96:99]
    ds_write_b128 v7, v[100:103] offset:1024
    s_waitcnt vmcnt(0)
    s_branch L_wkv_x
L_gf:
    v_mov_b64 v[16:17], 0
    v_mov_b64 v[18:19], 0
    v_mov_b64 v[20:21], 0
    v_mov_b64 v[22:23], 0
    v_mov_b64 v[24:25], 0
    v_mov_b64 v[26:27], 0
    v_mov_b64 v[28:29], 0
    v_mov_b64 v[30:31], 0
    v_mov_b64 v[32:33], 0
    v_mov_b64 v[34:35], 0
    v_mov_b64 v[36:37], 0
    v_mov_b64 v[38:39], 0
    v_mov_b64 v[40:41], 0
    v_mov_b64 v[42:43], 0
    v_mov_b64 v[44:45], 0
    v_mov_b64 v[46:47], 0
    v_mov_b64 v[48:49], 0
    v_mov_b64 v[50:51], 0
    v_mov_b64 v[52:53], 0
    v_mov_b64 v[54:55], 0
    v_mov_b64 v[56:57], 0
    v_mov_b64 v[58:59], 0
    v_mov_b64 v[60:61], 0
    v_mov_b64 v[62:63], 0
    v_mov_b64 v[64:65], 0
    v_mov_b64 v[66:67], 0
    v_mov_b64 v[68:69], 0
    v_mov_b64 v[70:71], 0
    v_mov_b64 v[72:73], 0
    v_mov_b64 v[74:75], 0
    v_mov_b64 v[76:77], 0
    v_mov_b64 v[78:79], 0
    v_mov_b64 v[104:105], 0
    v_mov_b64 v[106:107], 0
    v_mov_b64 v[108:109], 0
    v_mov_b64 v[110:111], 0
L_g0:
    s_lshl_b32 s69, s57, 4
    s_add_u32 s69, s69, s4
    s_lshl_b32 s69, s69, 4
    s_add_u32 s69, s69, s5
    s_lshl_b32 s69, s69, 7
    s_add_u32 s69, s69, 10485760
    v_mov_b32 v6, s52
    v_lshlrev_b32 v5, 7, v0
    s_lshr_b32 s62, s4, 1
    s_lshl_b32 s62, s62, 12
    s_add_u32 s62, s62, 10485760
    s_setprio 1
    s_cmp_lg_u32 s57, 0
    s_cbranch_scc1 L_g1
    s_waitcnt vmcnt(0)
    s_mov_b64 exec, 1
    buffer_store_dword v6, off, s[16:19], s69 sc1
    s_barrier
    s_branch L_g2
L_g1:
    s_barrier
    buffer_store_dwordx4 v[152:155], v7, s[16:19], s44 offen sc1
    buffer_store_dwordx4 v[156:159], v7, s[16:19], s45 offen sc1
    buffer_store_dwordx4 v[160:163], v7, s[16:19], s46 offen sc1
    buffer_store_dwordx4 v[164:167], v7, s[16:19], s47 offen sc1
    s_waitcnt vmcnt(0)
    s_mov_b64 exec, 1
    buffer_store_dword v6, off, s[16:19], s69 sc1
L_g2:
    s_cbranch_scc1 L_wkv_x
    s_mov_b32 exec_lo, -1
    s_waitcnt vmcnt(0)
    s_mov_b32 s53, 262144
L_wkv:
    buffer_load_dword v6, v5, s[16:19], s62 offen sc1
    s_sub_u32 s53, s53, 1
    s_cbranch_scc1 L_wkv_x
    s_waitcnt vmcnt(0)
    v_cmp_ne_u32 vcc, s52, v6
    s_cbranch_vccz L_wkv_x
    s_sleep 2
    s_branch L_wkv
L_wkv_x:
    s_mov_b64 exec, -1
    v_mov_b64 v[132:133], v[12:13]
    v_mov_b64 v[134:135], v[12:13]
    v_mov_b64 v[136:137], v[12:13]
    v_mov_b64 v[138:139], v[12:13]
    v_mov_b64 v[144:145], v[12:13]
    v_mov_b64 v[146:147], v[12:13]
    v_mov_b64 v[148:149], v[12:13]
    v_mov_b64 v[150:151], v[12:13]
    s_waitcnt lgkmcnt(0)
    s_barrier
    buffer_load_dwordx4 v[128:131], v14, s[20:23], s60 offen offset:0 sc1
    s_mov_b64 exec, s[64:65]
    buffer_load_dwordx4 v[132:135], v4, s[20:23], s60 offen offset:1024 sc1
    buffer_load_dwordx4 v[136:139], v4, s[20:23], s60 offen offset:1536 sc1
    s_mov_b64 exec, -1
    buffer_load_dwordx4 v[140:143], v14, s[20:23], s60 offen offset:2048 sc1
    v_xor_b32 v8, 0x3000, v1
    v_xor_b32 v9, 0x2000, v1
    v_xor_b32 v10, 0x1000, v1
    ds_read_b128 v[112:115], v8
    ds_read_b128 v[116:119], v9
    ds_read_b128 v[120:123], v10
    ds_read_b128 v[124:127], v1
    s_lshl_b32 s61, s5, 4
    s_add_u32 s61, s61, s4
    s_lshl_b32 s61, s61, 3
    s_add_u32 s61, s61, s54
    s_lshl_b32 s61, s61, 8
    s_add_u32 s61, s61, 11534336
    v_lshlrev_b32 v5, 7, v0
    s_lshl_b32 s53, s54, 13
    v_add_u32 v11, s53, v14
L_stub4:
    s_cbranch_execz L_stub11
    s_nop 0
    v_xor_b32 v10, 0x4000, v11
    v_xor_b32 v9, 0x8000, v11
    v_xor_b32 v8, 0xc000, v11
    s_lshl_b32 s53, s5, 1
    s_lshr_b32 s59, s4, 3
    s_add_u32 s53, s53, s59
    s_lshl_b32 s53, s53, 1
    s_and_b32 s59, s4, 1
    s_add_u32 s53, s53, s59
    s_lshl_b32 s53, s53, 3
    s_add_u32 s53, s53, s54
    s_lshl_b32 s53, s53, 12
    s_add_u32 s62, s53, 4194304
    s_lshl_b32 s53, s54, 12
    s_add_u32 s53, s53, 65536
    v_add_u32 v1, s53, v14
    v_mov_b32 v3, 131072
    s_lshl_b32 s53, s54, 2
    v_add_u32 v15, s53, v3
    s_mov_b32 s40, 813694976
    s_mov_b32 s41, 587202560
    s_movk_i32 s42, 0x207
    v_mov_b32 v6, 0
    s_movk_i32 s43, 0x400
    s_mov_b32 s59, 0
    s_cmp_ge_u32 s54, 4
    s_waitcnt lgkmcnt(0)
    s_barrier
    s_cbranch_scc1 L_nz
    v_mov_b64 v[16:17], 0
    v_mov_b64 v[18:19], 0
    v_mov_b64 v[20:21], 0
    v_mov_b64 v[22:23], 0
    v_mov_b64 v[24:25], 0
    v_mov_b64 v[26:27], 0
    v_mov_b64 v[28:29], 0
    v_mov_b64 v[30:31], 0
    v_mov_b64 v[32:33], 0
    v_mov_b64 v[34:35], 0
    v_mov_b64 v[36:37], 0
    v_mov_b64 v[38:39], 0
    v_mov_b64 v[40:41], 0
    v_mov_b64 v[42:43], 0
    v_mov_b64 v[44:45], 0
    v_mov_b64 v[46:47], 0
    v_mov_b64 v[48:49], 0
    v_mov_b64 v[50:51], 0
    v_mov_b64 v[52:53], 0
    v_mov_b64 v[54:55], 0
    v_mov_b64 v[56:57], 0
    v_mov_b64 v[58:59], 0
    v_mov_b64 v[60:61], 0
    v_mov_b64 v[62:63], 0
    v_mov_b64 v[64:65], 0
    v_mov_b64 v[66:67], 0
    v_mov_b64 v[68:69], 0
    v_mov_b64 v[70:71], 0
    v_mov_b64 v[72:73], 0
    v_mov_b64 v[74:75], 0
    v_mov_b64 v[76:77], 0
    v_mov_b64 v[78:79], 0
    v_mov_b64 v[104:105], 0
    v_mov_b64 v[106:107], 0
    v_mov_b64 v[108:109], 0
    v_mov_b64 v[110:111], 0
L_nz:
    s_waitcnt vmcnt(3)
    v_mfma_f32_32x32x16_bf16 v[80:95], v[128:131], v[112:115], 0
    s_nop 11
.p2align 3
L_att:
    s_cmp_lg_u32 s59, 6
    s_cbranch_scc1 L_nps
    s_setprio 0
L_nps:
    s_add_u32 s59, s59, 1
    v_exp_f32 v80, v80
    v_exp_f32 v81, v81
    v_smfmac_f32_32x32x32_bf16 v[64:79], v[148:151], v[104:111], v2
    v_exp_f32 v82, v82
    v_exp_f32 v83, v83
    v_mfma_f32_32x32x16_bf16 v[96:111], v[128:131], v[116:119], 0
    v_exp_f32 v84, v84
    s_mov_b64 exec, s[64:65]
    buffer_load_dwordx4 v[144:147], v4, s[20:23], s60 offen offset:3072 sc1
    buffer_load_dwordx4 v[148:151], v4, s[20:23], s60 offen offset:3584 sc1
    s_mov_b64 exec, -1
    v_exp_f32 v85, v85
    v_exp_f32 v86, v86
    v_exp_f32 v87, v87
    v_exp_f32 v88, v88
    v_exp_f32 v89, v89
    s_waitcnt vmcnt(3)
    s_addk_i32 s60, 0x1000
    v_smfmac_f32_32x32x32_bf16 v[16:31], v[132:135], v[80:87], v2
    v_exp_f32 v90, v90
    v_exp_f32 v91, v91
    v_exp_f32 v92, v92
    v_exp_f32 v93, v93
    v_exp_f32 v94, v94
    v_exp_f32 v95, v95
    v_exp_f32 v96, v96
    v_exp_f32 v97, v97
    v_smfmac_f32_32x32x32_bf16 v[16:31], v[136:139], v[88:95], v2
    v_exp_f32 v98, v98
    v_exp_f32 v99, v99
    v_mfma_f32_32x32x16_bf16 v[80:95], v[128:131], v[120:123], 0
    v_exp_f32 v100, v100
    v_exp_f32 v101, v101
    v_exp_f32 v102, v102
    v_exp_f32 v103, v103
    v_exp_f32 v104, v104
    v_exp_f32 v105, v105
    v_smfmac_f32_32x32x32_bf16 v[32:47], v[132:135], v[96:103], v2
    v_exp_f32 v106, v106
    v_exp_f32 v107, v107
    v_exp_f32 v108, v108
    v_exp_f32 v109, v109
    v_exp_f32 v110, v110
    v_exp_f32 v111, v111
    v_exp_f32 v80, v80
    v_exp_f32 v81, v81
    v_smfmac_f32_32x32x32_bf16 v[32:47], v[136:139], v[104:111], v2
    v_exp_f32 v82, v82
    v_exp_f32 v83, v83
    v_mfma_f32_32x32x16_bf16 v[96:111], v[128:131], v[124:127], 0
    buffer_load_dwordx4 v[128:131], v14, s[20:23], s60 offen offset:0 sc1
    v_exp_f32 v84, v84
    v_exp_f32 v85, v85
    v_exp_f32 v86, v86
    v_exp_f32 v87, v87
    v_exp_f32 v88, v88
    v_exp_f32 v89, v89
    v_smfmac_f32_32x32x32_bf16 v[48:63], v[132:135], v[80:87], v2
    v_exp_f32 v90, v90
    v_exp_f32 v91, v91
    v_exp_f32 v92, v92
    v_exp_f32 v93, v93
    v_exp_f32 v94, v94
    v_exp_f32 v95, v95
    v_exp_f32 v96, v96
    v_exp_f32 v97, v97
    v_smfmac_f32_32x32x32_bf16 v[48:63], v[136:139], v[88:95], v2
    v_exp_f32 v98, v98
    v_exp_f32 v99, v99
    v_exp_f32 v100, v100
    s_waitcnt vmcnt(3)
    v_mfma_f32_32x32x16_bf16 v[80:95], v[140:143], v[112:115], 0
    v_exp_f32 v101, v101
    v_exp_f32 v102, v102
    v_exp_f32 v103, v103
    v_exp_f32 v104, v104
    v_exp_f32 v105, v105
    v_exp_f32 v106, v106
    v_smfmac_f32_32x32x32_bf16 v[64:79], v[132:135], v[96:103], v2
    v_exp_f32 v107, v107
    v_exp_f32 v108, v108
    v_exp_f32 v109, v109
    v_exp_f32 v110, v110
    v_exp_f32 v111, v111
    s_nop 0
    v_exp_f32 v80, v80
    v_exp_f32 v81, v81
    v_smfmac_f32_32x32x32_bf16 v[64:79], v[136:139], v[104:111], v2
    v_exp_f32 v82, v82
    v_exp_f32 v83, v83
    v_mfma_f32_32x32x16_bf16 v[96:111], v[140:143], v[116:119], 0
    v_exp_f32 v84, v84
    s_mov_b64 exec, s[64:65]
    buffer_load_dwordx4 v[132:135], v4, s[20:23], s60 offen offset:1024 sc1
    buffer_load_dwordx4 v[136:139], v4, s[20:23], s60 offen offset:1536 sc1
    s_mov_b64 exec, -1
    v_exp_f32 v85, v85
    v_exp_f32 v86, v86
    v_exp_f32 v87, v87
    v_exp_f32 v88, v88
    v_exp_f32 v89, v89
    s_waitcnt vmcnt(3)
    s_nop 0
    v_smfmac_f32_32x32x32_bf16 v[16:31], v[144:147], v[80:87], v2
    v_exp_f32 v90, v90
    v_exp_f32 v91, v91
    v_exp_f32 v92, v92
    v_exp_f32 v93, v93
    v_exp_f32 v94, v94
    v_exp_f32 v95, v95
    v_exp_f32 v96, v96
    v_exp_f32 v97, v97
    v_smfmac_f32_32x32x32_bf16 v[16:31], v[148:151], v[88:95], v2
    v_exp_f32 v98, v98
    v_exp_f32 v99, v99
    v_mfma_f32_32x32x16_bf16 v[80:95], v[140:143], v[120:123], 0
    ds_read_b32 v7, v3 offset:12
    v_exp_f32 v100, v100
    v_exp_f32 v101, v101
    v_exp_f32 v102, v102
    v_exp_f32 v103, v103
    v_exp_f32 v104, v104
    v_exp_f32 v105, v105
    v_smfmac_f32_32x32x32_bf16 v[32:47], v[144:147], v[96:103], v2
    v_exp_f32 v106, v106
    v_exp_f32 v107, v107
    v_exp_f32 v108, v108
    v_exp_f32 v109, v109
    v_exp_f32 v110, v110
    v_exp_f32 v111, v111
    v_exp_f32 v80, v80
    v_exp_f32 v81, v81
    v_smfmac_f32_32x32x32_bf16 v[32:47], v[148:151], v[104:111], v2
    v_exp_f32 v82, v82
    v_exp_f32 v83, v83
    v_mfma_f32_32x32x16_bf16 v[96:111], v[140:143], v[124:127], 0
    buffer_load_dwordx4 v[140:143], v14, s[20:23], s60 offen offset:2048 sc1
    v_exp_f32 v84, v84
    v_exp_f32 v85, v85
    v_exp_f32 v86, v86
    v_exp_f32 v87, v87
    v_exp_f32 v88, v88
    v_exp_f32 v89, v89
    v_smfmac_f32_32x32x32_bf16 v[48:63], v[144:147], v[80:87], v2
L_stub5:
    s_cbranch_execz L_stub10
    s_nop 0
    v_exp_f32 v90, v90
    v_exp_f32 v91, v91
    v_exp_f32 v92, v92
    v_exp_f32 v93, v93
    v_exp_f32 v94, v94
    v_exp_f32 v95, v95
    v_exp_f32 v96, v96
    v_exp_f32 v97, v97
    v_smfmac_f32_32x32x32_bf16 v[48:63], v[148:151], v[88:95], v2
    v_exp_f32 v98, v98
    v_exp_f32 v99, v99
    v_exp_f32 v100, v100
    s_waitcnt vmcnt(3)
    v_mfma_f32_32x32x16_bf16 v[80:95], v[128:131], v[112:115], 0
    v_exp_f32 v101, v101
    v_exp_f32 v102, v102
    v_exp_f32 v103, v103
    v_exp_f32 v104, v104
    v_exp_f32 v105, v105
    v_exp_f32 v106, v106
    v_smfmac_f32_32x32x32_bf16 v[64:79], v[144:147], v[96:103], v2
    v_exp_f32 v107, v107
    v_exp_f32 v108, v108
    v_exp_f32 v109, v109
    v_exp_f32 v110, v110
    v_exp_f32 v111, v111
    s_cmp_lt_u32 s59, 8
    s_waitcnt lgkmcnt(0)
    v_cmp_gt_u32 vcc, s43, v7
    s_cbranch_vccnz L_sw
L_swx:
    s_cbranch_scc1 L_att
    v_cmp_ne_u32 vcc, 0x404, v7
    v_smfmac_f32_32x32x32_bf16 v[64:79], v[148:151], v[104:111], v2
    s_cbranch_vccz L_d3_x
    s_mov_b32 s53, 2097152
L_d3:
    ds_read_b32 v7, v3 offset:12
    s_sub_u32 s53, s53, 1
    s_cbranch_scc1 L_d3_x
    s_waitcnt lgkmcnt(0)
    v_cmp_ne_u32 vcc, 0x404, v7
    s_cbranch_vccz L_d3_x
    s_sleep 1
    s_branch L_d3
L_d3_x:
    ds_write_b128 v8, v[16:19] offset:0
    ds_write_b128 v8, v[20:23] offset:1024
    ds_write_b32 v8, v24 offset:6144
    ds_write_b128 v9, v[32:35] offset:2048
    ds_write_b128 v9, v[36:39] offset:3072
    ds_write_b32 v9, v40 offset:6148
    ds_write_b128 v10, v[48:51] offset:4096
    ds_write_b128 v10, v[52:55] offset:5120
    ds_write_b32 v10, v56 offset:6152
    s_waitcnt lgkmcnt(0)
    s_setprio 2
    s_barrier
    ds_read_b128 v[40:43], v11 offset:6144
    ds_read_b128 v[16:19], v11 offset:0
    ds_read_b128 v[20:23], v11 offset:1024
    ds_read_b128 v[24:27], v11 offset:2048
    ds_read_b128 v[28:31], v11 offset:3072
    ds_read_b128 v[32:35], v11 offset:4096
    ds_read_b128 v[36:39], v11 offset:5120
    s_waitcnt lgkmcnt(4)
    v_add_f32 v72, v72, v40
    v_add_f32 v41, v41, v42
    v_pk_add_f32 v[64:65], v[64:65], v[16:17]
    v_pk_add_f32 v[66:67], v[66:67], v[18:19]
    v_pk_add_f32 v[68:69], v[68:69], v[20:21]
    v_pk_add_f32 v[70:71], v[70:71], v[22:23]
    v_add_f32 v72, v72, v41
    s_waitcnt lgkmcnt(2)
    v_pk_add_f32 v[64:65], v[64:65], v[24:25]
    v_pk_add_f32 v[66:67], v[66:67], v[26:27]
    v_pk_add_f32 v[68:69], v[68:69], v[28:29]
    v_pk_add_f32 v[70:71], v[70:71], v[30:31]
    s_waitcnt lgkmcnt(0)
    v_pk_add_f32 v[64:65], v[64:65], v[32:33]
    v_pk_add_f32 v[66:67], v[66:67], v[34:35]
    v_pk_add_f32 v[68:69], v[68:69], v[36:37]
    v_pk_add_f32 v[70:71], v[70:71], v[38:39]
    v_subrev_u32 v9, s40, v72
    v_pk_add_f32 v[10:11], v[64:65], v[66:67]
    v_pk_add_f32 v[12:13], v[68:69], v[70:71]
    v_cmp_lt_u32 vcc, s41, v9
    v_pk_add_f32 v[10:11], v[10:11], v[12:13]
    v_add_f32 v10, v10, v11
    v_cmp_class_f32 s[66:67], v10, s42
    s_or_b64 vcc, vcc, s[66:67]
    s_cbranch_scc1 L_slow
L_fin:
    v_rcp_f32 v8, v72
    s_mov_b32 s60, 262144
    v_pk_mul_f32 v[64:65], v[64:65], v[8:9] op_sel_hi:[1,0]
    v_pk_mul_f32 v[66:67], v[66:67], v[8:9] op_sel_hi:[1,0]
    v_pk_mul_f32 v[68:69], v[68:69], v[8:9] op_sel_hi:[1,0]
    v_pk_mul_f32 v[70:71], v[70:71], v[8:9] op_sel_hi:[1,0]
    v_cvt_pk_bf16_f32 v16, v64, v65
    v_cvt_pk_bf16_f32 v17, v66, v67
    v_cvt_pk_bf16_f32 v18, v68, v69
    v_cvt_pk_bf16_f32 v19, v70, v71
    v_min_u32 v16, -2, v16
    v_min_u32 v17, -2, v17
    v_min_u32 v18, -2, v18
    v_min_u32 v19, -2, v19
    buffer_store_dwordx4 v[16:19], v14, s[16:19], s63 offen sc1
    s_mov_b64 exec, 3
    buffer_atomic_or v6, v5, s[16:19], s61 offen sc0 sc1
    s_mov_b64 exec, -1
L_na:
    s_setprio 0
    s_lshl_b32 s53, s54, 10
    s_add_u32 s53, s53, 141312
    v_add_u32 v11, s53, v14
    ds_read_b128 v[24:27], v11
    v_lshrrev_b32 v8, 3, v0
    v_and_b32 v9, 7, v0
    v_mul_u32_u24 v12, 1040, v9
    v_lshl_add_u32 v12, v8, 1, v12
    s_lshl_b32 s53, s54, 4
    s_add_u32 s53, s53, 149504
    v_add_u32 v12, s53, v12
    ds_read_u16 v32, v12 offset:0
    ds_read_u16 v33, v12 offset:128
    ds_read_u16 v34, v12 offset:256
    ds_read_u16 v35, v12 offset:384
    ds_read_u16 v36, v12 offset:512
    ds_read_u16 v37, v12 offset:640
    ds_read_u16 v38, v12 offset:768
    ds_read_u16 v39, v12 offset:896
    v_and_b32 v10, 3, v8
    v_lshrrev_b32 v8, 2, v8
    v_lshlrev_b32 v13, 4, v9
    v_lshl_add_u32 v13, v10, 11, v13
    v_lshl_add_u32 v13, v8, 20, v13
    s_mov_b32 s53, 0xffff0000
    s_waitcnt lgkmcnt(0)
    v_lshlrev_b32 v32, 16, v32
    v_lshlrev_b32 v33, 16, v33
    v_lshlrev_b32 v40, 16, v24
    v_and_b32 v41, s53, v24
    v_lshlrev_b32 v34, 16, v34
    v_lshlrev_b32 v35, 16, v35
    v_lshlrev_b32 v42, 16, v25
    v_and_b32 v43, s53, v25
    v_lshlrev_b32 v36, 16, v36
    v_lshlrev_b32 v37, 16, v37
    v_lshlrev_b32 v44, 16, v26
    v_and_b32 v45, s53, v26
    v_lshlrev_b32 v38, 16, v38
    v_lshlrev_b32 v39, 16, v39
    v_lshlrev_b32 v46, 16, v27
    v_and_b32 v47, s53, v27
    v_pk_mul_f32 v[32:33], v[32:33], v[40:41]
    v_pk_mul_f32 v[34:35], v[34:35], v[42:43]
    v_pk_mul_f32 v[36:37], v[36:37], v[44:45]
    v_pk_mul_f32 v[38:39], v[38:39], v[46:47]
    v_cvt_pk_bf16_f32 v20, v32, v33
    v_cvt_pk_bf16_f32 v21, v34, v35
    v_cvt_pk_bf16_f32 v22, v36, v37
    v_cvt_pk_bf16_f32 v23, v38, v39
    s_mov_b64 exec, 3
    s_waitcnt vmcnt(0)
    v_cmp_ne_u32 vcc, s52, v6
    s_cbranch_vccz L_wh_x
    s_mov_b32 s53, 262144
L_wh:
    v_mov_b32 v6, 0
    buffer_atomic_or v6, v5, s[16:19], s61 offen sc0 sc1
    s_sub_u32 s53, s53, 1
    s_cbranch_scc1 L_wh_x
    s_waitcnt vmcnt(0)
    v_cmp_ne_u32 vcc, s52, v6
    s_cbranch_vccz L_wh_x
    s_sleep 1
    s_branch L_wh
L_wh_x:
    s_mov_b64 exec, -1
L_wo2:
    s_waitcnt lgkmcnt(0)
    buffer_load_dwordx4 v[96:99], v14, s[16:19], s62 offen offset:0 sc1
    buffer_load_dwordx4 v[100:103], v14, s[16:19], s62 offen offset:1024 sc1
L_stub6:
    s_cbranch_execz L_stub9
    s_nop 0
    buffer_load_dwordx4 v[104:107], v14, s[16:19], s62 offen offset:2048 sc1
    buffer_load_dwordx4 v[108:111], v14, s[16:19], s62 offen offset:3072 sc1
    s_waitcnt vmcnt(2)
    ds_write_b128 v1, v[96:99]
    ds_write_b128 v1, v[100:103] offset:1024
    v_max3_u32 v9, v96, v97, v98
    v_max3_u32 v10, v99, v100, v101
    v_max3_u32 v9, v102, v103, v9
    s_waitcnt vmcnt(0)
    ds_write_b128 v1, v[104:107] offset:2048
    ds_write_b128 v1, v[108:111] offset:3072
    v_max3_u32 v10, v104, v105, v10
    v_max3_u32 v9, v106, v107, v9
    v_max3_u32 v10, v108, v109, v10
    v_max3_u32 v9, v110, v111, v9
    v_max_u32 v9, v9, v10
    s_sub_u32 s60, s60, 1
    v_cmp_eq_u32 vcc, -1, v9
    s_cbranch_scc1 L_wo2_x
    s_cbranch_vccnz L_wo2
L_wo2_x:
    ds_write_b32 v15, v2 offset:32
    buffer_store_dwordx4 v[20:23], v13, s[24:27], s49 offen offset:1024 sc1
    s_barrier
    s_endpgm
L_sw:
    s_mov_b32 s53, 2097152
L_sw1:
    ds_read_b32 v7, v3 offset:12
    s_sub_u32 s53, s53, 1
    s_cbranch_scc1 L_sw2
    s_waitcnt lgkmcnt(0)
    v_cmp_gt_u32 vcc, s43, v7
    s_cbranch_vccz L_sw2
    s_sleep 1
    s_branch L_sw1
L_sw2:
    s_waitcnt lgkmcnt(0)
    s_cmp_lt_u32 s59, 8
    s_branch L_swx
L_slow:
    s_waitcnt vmcnt(0)
    s_mov_b32 s60, s68
    s_add_u32 s59, s68, 131072
    v_mov_b32 v9, 0xff800000
L_s1:
    buffer_load_dwordx4 v[128:131], v14, s[16:19], s60 offen offset:0 sc1
    s_addk_i32 s60, 0x800
    s_waitcnt vmcnt(0)
    v_mfma_f32_32x32x16_bf16 v[80:95], v[128:131], v[124:127], 0
    s_nop 15
    v_max3_f32 v9, v80, v81, v9
    v_max3_f32 v9, v82, v83, v9
    v_max3_f32 v9, v84, v85, v9
    v_max3_f32 v9, v86, v87, v9
    v_max3_f32 v9, v88, v89, v9
    v_max3_f32 v9, v90, v91, v9
    v_max3_f32 v9, v92, v93, v9
    v_max3_f32 v9, v94, v95, v9
    s_cmp_lt_u32 s60, s59
    s_cbranch_scc1 L_s1
    v_mov_b32 v10, v9
    s_nop 1
    v_permlane32_swap_b32 v9, v10
    s_mov_b32 s60, s68
    s_nop 0
    v_max_f32 v9, v9, v10
    v_mov_b64 v[64:65], 0
    v_mov_b64 v[66:67], 0
    v_mov_b64 v[68:69], 0
    v_mov_b64 v[70:71], 0
    v_mov_b64 v[72:73], 0
    v_mov_b64 v[74:75], 0
    v_mov_b64 v[76:77], 0
    v_mov_b64 v[78:79], 0
L_s2:
    buffer_load_dwordx4 v[128:131], v14, s[16:19], s60 offen offset:0 sc1
    s_mov_b64 exec, s[64:65]
    buffer_load_dwordx4 v[132:135], v4, s[16:19], s60 offen offset:1024 sc1
    buffer_load_dwordx4 v[136:139], v4, s[16:19], s60 offen offset:1536 sc1
    s_mov_b64 exec, -1
    s_addk_i32 s60, 0x800
    s_waitcnt vmcnt(0)
    v_mfma_f32_32x32x16_bf16 v[80:95], v[128:131], v[124:127], 0
    s_nop 15
    v_sub_f32 v80, v80, v9
    v_sub_f32 v81, v81, v9
    v_sub_f32 v82, v82, v9
    v_sub_f32 v83, v83, v9
    v_sub_f32 v84, v84, v9
    v_sub_f32 v85, v85, v9
    v_sub_f32 v86, v86, v9
    v_sub_f32 v87, v87, v9
    v_sub_f32 v88, v88, v9
    v_sub_f32 v89, v89, v9
    v_sub_f32 v90, v90, v9
    v_sub_f32 v91, v91, v9
    v_sub_f32 v92, v92, v9
    v_sub_f32 v93, v93, v9
    v_sub_f32 v94, v94, v9
    v_sub_f32 v95, v95, v9
    v_exp_f32 v80, v80
    v_exp_f32 v81, v81
    v_exp_f32 v82, v82
    v_exp_f32 v83, v83
    v_exp_f32 v84, v84
    v_exp_f32 v85, v85
    v_exp_f32 v86, v86
    v_exp_f32 v87, v87
    v_exp_f32 v88, v88
    v_exp_f32 v89, v89
    v_exp_f32 v90, v90
    v_exp_f32 v91, v91
    v_exp_f32 v92, v92
    v_exp_f32 v93, v93
    v_exp_f32 v94, v94
    v_exp_f32 v95, v95
    s_nop 1
    v_smfmac_f32_32x32x32_bf16 v[64:79], v[132:135], v[80:87], v2
    v_smfmac_f32_32x32x32_bf16 v[64:79], v[136:139], v[88:95], v2
    s_cmp_lt_u32 s60, s59
    s_cbranch_scc1 L_s2
    s_nop 15
    s_branch L_fin
.section .rodata,"a"
.p2align 6
.amdhsa_kernel concat_heads__mha_block__ssm_conv_h3__prompt_kernel
  .amdhsa_next_free_vgpr 168
  .amdhsa_next_free_sgpr 96
  .amdhsa_accum_offset 168
  .amdhsa_group_segment_fixed_size 0
  .amdhsa_kernarg_size 96
  .amdhsa_user_sgpr_count 2
  .amdhsa_user_sgpr_kernarg_segment_ptr 1
  .amdhsa_system_sgpr_workgroup_id_x 1
.end_amdhsa_kernel
```
